```python
import torch

def _softmax(x, axis=-1):
    return torch.softmax(x, dim=axis)
def _gelu(x):
    return torch.nn.functional.gelu(x, approximate="tanh")
def _silu(x):
    return torch.nn.functional.silu(x)
def _sigmoid(x):
    return torch.sigmoid(x)
def _layernorm(x, axis=-1, eps=1e-5):
    m = x.mean(dim=axis, keepdim=True)
    v = x.var(dim=axis, keepdim=True, unbiased=False)
    return (x - m) / torch.sqrt(v + eps)
def _scatter_add(tgt, idx, src, axis=0):
    return tgt.clone().index_add_(axis, idx, src)
def _segment_sum(src, seg, n):
    out = torch.zeros((n,) + src.shape[1:], dtype=src.dtype)
    return out.index_add_(0, seg, src)
def _pad(x, pw):
    flat = tuple(v for pair in reversed(pw) for v in pair)
    return torch.nn.functional.pad(x, flat)

kernel_name = 'parallel_sum__softmax_full_mha__glu_gated_reglu__prompt'

def setup_inputs():

    _w = (lambda a: (lambda t: t.to(torch.bfloat16) if t.is_floating_point() else t)(torch.as_tensor(a)))
    def _A_setup():
        B, S, D = 1, 2048, 512
        return {
            "x": _w((lambda *s: torch.randn(*s, dtype=torch.bfloat16) * 0.05)(B, S, D)),
            "wqkv": _w((lambda *s: torch.randn(*s, dtype=torch.bfloat16) * 0.05)(D, 3 * D)),
            "wo": _w((lambda *s: torch.randn(*s, dtype=torch.bfloat16) * 0.05)(D, D)),
        }
    _A_in = _A_setup()

    def _B_setup():
        B, S, D, F = 1, 2048, 512, 1792
        return {
            "x": _w((lambda *s: torch.randn(*s, dtype=torch.bfloat16) * 0.05)(B, S, D)),
            "W_gate": _w((lambda *s: torch.randn(*s, dtype=torch.bfloat16) * 0.4)(D, F) * (2.0 / D) ** 0.5),
            "W_up": _w((lambda *s: torch.randn(*s, dtype=torch.bfloat16) * 0.4)(D, F) * (2.0 / D) ** 0.5),
            "W_down": _w((lambda *s: torch.randn(*s, dtype=torch.bfloat16) * 0.4)(F, D) * (1.0 / F) ** 0.5),
        }
    _B_in = _B_setup()

    return {
        "A_x": _A_in["x"],
        "A_wqkv": _A_in["wqkv"],
        "A_wo": _A_in["wo"],
        "B_x": _B_in["x"],
        "B_W_gate": _B_in["W_gate"],
        "B_W_up": _B_in["W_up"],
        "B_W_down": _B_in["W_down"],
    }

def reference(A_x, A_wqkv, A_wo, B_x, B_W_gate, B_W_up, B_W_down):
    def _A_ref(x, wqkv, wo):
        B, S, D = x.shape
        H = 32; Dh = D // H
        qkv = (lambda x, *d: x.permute(*d))((x @ wqkv).reshape(B, S, 3, H, Dh), 2, 0, 3, 1, 4)
        q, k, v = qkv[0], qkv[1], qkv[2]
        scale = Dh ** -0.5
        scores = torch.einsum("bhqd,bhkd->bhqk", q, k) * scale
        p = _softmax(scores, axis=-1)
        o = torch.einsum("bhqk,bhkd->bhqd", p, v)
        return (lambda x, *d: x.permute(*d))(o, 0, 2, 1, 3).reshape(B, S, D) @ wo

    def _B_ref(x, W_gate, W_up, W_down):
        gate = torch.einsum("bsd,df->bsf", x, W_gate)
        up = torch.einsum("bsd,df->bsf", x, W_up)
        gate = gate * (lambda x, dt: x.to(dt))(gate > 0, gate.dtype)
        h = gate * up
        return torch.einsum("bsf,fd->bsd", h, W_down)

    x = A_x
    xn = _layernorm(x, axis=-1)
    return x + _A_ref(xn, A_wqkv, A_wo) + _B_ref(xn, B_W_gate, B_W_up, B_W_down)
```

```asm
; @launch grid=(256,1,1) block=(512,1,1) lds=163840
.amdgcn_target "amdgcn-amd-amdhsa--gfx950"
.text
.globl parallel_sum__softmax_full_mha__glu_gated_reglu__prompt_kernel
.p2align 8
.type parallel_sum__softmax_full_mha__glu_gated_reglu__prompt_kernel,@function
parallel_sum__softmax_full_mha__glu_gated_reglu__prompt_kernel:
  s_cmp_ge_u32 s2, 0x100
  s_cbranch_scc1 L_end
  s_load_dwordx4 s[4:7], s[0:1], 0
  s_load_dwordx2 s[22:23], s[0:1], 72
  s_load_dwordx2 s[8:9], s[0:1], 16
  s_load_dwordx8 s[12:19], s[0:1], 32
  v_lshrrev_b32 v1, 6, v0
  v_and_b32 v0, 63, v0
  s_and_b32 s3, s2, 7
  s_lshr_b32 s10, s2, 3
  v_readfirstlane_b32 s11, v1
  s_and_b32 s62, s3, 1
  s_lshl_b32 s62, s62, 2
  s_and_b32 s68, s10, 3
  s_or_b32 s62, s62, s68
  s_lshr_b32 s61, s3, 1
  s_lshl_b32 s61, s61, 3
  s_lshr_b32 s68, s10, 2
  s_or_b32 s61, s61, s68
  s_and_b32 s21, s10, 3
  s_lshl_b32 s21, s21, 1
  s_add_u32 s21, s21, s68
  s_and_b32 s21, s21, 7
  s_getpc_b64 s[56:57]
L_pc:
  s_lshl3_add_u32 s69, s10, s11
  s_lshl_b32 s69, s69, 7
  s_min_u32 s69, s69, L_code_end-L_pc-4
  s_add_u32 s56, s56, s69
  s_addc_u32 s57, s57, 0
  v_mov_b32 v254, s56
  v_mov_b32 v255, s57
  global_load_dword v253, v[254:255], off
  s_and_b32 s60, s11, 3
  s_cmp_lt_u32 s11, 4
  s_cbranch_scc1 L_ln
  v_lshrrev_b32 v2, 3, v0
  v_lshrrev_b32 v1, 2, v0
  v_and_b32 v1, 4, v1
  v_xor_b32 v15, v0, v1
  v_and_b32 v12, 7, v15
  s_lshl_b32 s68, s60, 4
  v_add_u32 v15, s68, v2
  v_mul_u32_u24 v15, 0xc00, v15
  s_lshl_b32 s68, s62, 7
  v_lshl_add_u32 v15, v12, 4, v15
  v_add_u32 v96, s68, v15
  v_add_u32 v97, 0x5c00, v96
  v_add_u32 v98, 0x400, v96
  v_add_u32 v99, 0x6000, v96
  v_add_u32 v100, 0x800, v96
  v_add_u32 v101, 0x6400, v96
  s_mul_i32 s70, s60, 0x1800
  s_add_u32 s70, s70, 0x10000
  s_waitcnt lgkmcnt(0)
  s_mov_b32 s28, s6
  s_mov_b32 s29, s7
  s_mov_b32 s30, 0x180000
  s_mov_b32 s31, 0x20000
  s_load_dword s75, s[22:23], 0x0
  s_mov_b32 s24, s4
  s_mov_b32 s25, s5
  s_mov_b32 s26, 0x200000
  s_mov_b32 s27, 0x20000
  s_mov_b32 s32, s12
  s_mov_b32 s33, s13
  s_mov_b32 s34, 0x1c0000
  s_mov_b32 s35, 0x20000
  s_mov_b32 s36, s14
  s_mov_b32 s37, s15
  s_mov_b32 s38, 0x1c0000
  s_mov_b32 s39, 0x20000
  s_mov_b32 s40, s16
  s_mov_b32 s41, s17
  s_mov_b32 s42, 0x1c0000
  s_mov_b32 s43, 0x20000
  s_mov_b32 s44, s8
  s_mov_b32 s45, s9
  s_mov_b32 s46, 0x80000
  s_mov_b32 s47, 0x20000
  s_mov_b32 s48, s18
  s_mov_b32 s49, s19
  s_mov_b32 s50, 0x200000
  s_mov_b32 s51, 0x20000
  s_mov_b32 s52, s22
  s_mov_b32 s53, s23
  s_mov_b32 s54, 0x1100000
  s_mov_b32 s55, 0x20000
  s_barrier
  s_xor_b32 s67, s21, 0
  s_mul_i32 s67, s67, 0x30000
  s_add_u32 m0, s70, 0x0
  s_nop 0
  buffer_load_dwordx4 v96, s[28:31], s67 offen lds
  buffer_load_dwordx4 v97, s[28:31], s67 offen offset:1024 lds
  s_add_u32 m0, s70, 0x800
  s_nop 0
  buffer_load_dwordx4 v98, s[28:31], s67 offen lds
  buffer_load_dwordx4 v99, s[28:31], s67 offen offset:1024 lds
  s_add_u32 m0, s70, 0x1000
  s_nop 0
  buffer_load_dwordx4 v100, s[28:31], s67 offen lds
  buffer_load_dwordx4 v101, s[28:31], s67 offen offset:1024 lds
  s_xor_b32 s67, s21, 1
  s_mul_i32 s67, s67, 0x30000
  s_add_u32 m0, s70, 0x6000
  s_nop 0
  buffer_load_dwordx4 v96, s[28:31], s67 offen lds
  buffer_load_dwordx4 v97, s[28:31], s67 offen offset:1024 lds
  s_add_u32 m0, s70, 0x6800
  s_nop 0
  buffer_load_dwordx4 v98, s[28:31], s67 offen lds
  buffer_load_dwordx4 v99, s[28:31], s67 offen offset:1024 lds
  s_add_u32 m0, s70, 0x7000
  s_nop 0
  buffer_load_dwordx4 v100, s[28:31], s67 offen lds
  buffer_load_dwordx4 v101, s[28:31], s67 offen offset:1024 lds
  s_branch L_gemm
L_ln:
  v_lshrrev_b32 v2, 3, v0
  v_lshrrev_b32 v1, 2, v0
  v_and_b32 v1, 4, v1
  v_xor_b32 v15, v0, v1
  v_and_b32 v12, 7, v15
  s_lshl_b32 s68, s60, 4
  v_add_u32 v15, s68, v2
  v_mul_u32_u24 v15, 0xc00, v15
  s_lshl_b32 s68, s62, 7
  v_lshl_add_u32 v15, v12, 4, v15
  v_add_u32 v96, s68, v15
  v_add_u32 v97, 0x5c00, v96
  v_add_u32 v98, 0x400, v96
  v_add_u32 v99, 0x6000, v96
  v_add_u32 v100, 0x800, v96
  v_add_u32 v101, 0x6400, v96
  s_mul_i32 s73, s60, 0x1800
  s_add_u32 s73, s73, 0x10000
  v_lshrrev_b32 v2, 3, v0
  v_and_b32 v3, 7, v0
  v_lshlrev_b32 v4, 10, v2
  v_lshl_add_u32 v4, v3, 4, v4
  s_lshl2_add_u32 s68, s61, s60
  s_lshl_b32 s68, s68, 14
  s_lshl_b32 s69, s21, 7
  s_add_u32 s68, s68, s69
  v_add_u32 v14, 0x2000, v4
  s_xor_b32 s32, s68, 0x0
  s_xor_b32 s33, s68, 0x80
  s_xor_b32 s34, s68, 0x100
  s_xor_b32 s35, s68, 0x180
  s_xor_b32 s36, s68, 0x200
  s_xor_b32 s37, s68, 0x280
  s_xor_b32 s38, s68, 0x300
  s_xor_b32 s39, s68, 0x380
  v_xor_b32 v5, v2, v3
  v_lshlrev_b32 v5, 4, v5
  v_lshl_add_u32 v5, v3, 9, v5
  s_lshr_b32 s70, s60, 1
  s_lshl_b32 s70, s70, 15
  s_and_b32 s71, s60, 1
  s_lshl_b32 s71, s71, 8
  s_add_u32 s70, s70, s71
  v_add_u32 v5, s70, v5
  s_mov_b32 s70, 0x3f803f80
  s_mov_b32 s71, 0xffff0000
  v_mov_b32 v6, 0
  v_mov_b32 v7, 0
  v_mov_b32 v8, 0
  v_mov_b32 v9, 0
  s_and_b32 s68, s10, 3
  s_lshl2_add_u32 s63, s3, s68
  s_lshr_b32 s64, s10, 2
  s_waitcnt lgkmcnt(0)
  s_mov_b32 s24, s4
  s_mov_b32 s25, s5
  s_mov_b32 s26, 0x200000
  s_mov_b32 s27, 0x20000
  buffer_load_dwordx4 v[16:19], v4, s[24:27], s32 offen
  buffer_load_dwordx4 v[48:51], v14, s[24:27], s32 offen
  buffer_load_dwordx4 v[20:23], v4, s[24:27], s33 offen
  buffer_load_dwordx4 v[52:55], v14, s[24:27], s33 offen
  buffer_load_dwordx4 v[24:27], v4, s[24:27], s34 offen
  buffer_load_dwordx4 v[56:59], v14, s[24:27], s34 offen
  buffer_load_dwordx4 v[28:31], v4, s[24:27], s35 offen
  buffer_load_dwordx4 v[60:63], v14, s[24:27], s35 offen
  buffer_load_dwordx4 v[32:35], v4, s[24:27], s36 offen
  buffer_load_dwordx4 v[64:67], v14, s[24:27], s36 offen
  buffer_load_dwordx4 v[36:39], v4, s[24:27], s37 offen
  buffer_load_dwordx4 v[68:71], v14, s[24:27], s37 offen
  buffer_load_dwordx4 v[40:43], v4, s[24:27], s38 offen
  buffer_load_dwordx4 v[72:75], v14, s[24:27], s38 offen
  buffer_load_dwordx4 v[44:47], v4, s[24:27], s39 offen
  buffer_load_dwordx4 v[76:79], v14, s[24:27], s39 offen
  s_barrier
  s_load_dword s75, s[22:23], 0x0
  s_mov_b32 s52, s22
  s_mov_b32 s53, s23
  s_mov_b32 s54, 0x1100000
  s_mov_b32 s55, 0x20000
  s_mov_b32 s28, s6
  s_mov_b32 s29, s7
  s_mov_b32 s30, 0x180000
  s_mov_b32 s31, 0x20000
  s_waitcnt vmcnt(15)
  v_dot2c_f32_bf16 v6, s70, v16
  v_dot2c_f32_bf16 v7, v16, v16
  v_dot2c_f32_bf16 v6, s70, v17
  v_dot2c_f32_bf16 v7, v17, v17
  v_dot2c_f32_bf16 v6, s70, v18
  v_dot2c_f32_bf16 v7, v18, v18
  v_dot2c_f32_bf16 v6, s70, v19
  v_dot2c_f32_bf16 v7, v19, v19
  s_waitcnt vmcnt(14)
  v_dot2c_f32_bf16 v8, s70, v48
  v_dot2c_f32_bf16 v9, v48, v48
  v_dot2c_f32_bf16 v8, s70, v49
  v_dot2c_f32_bf16 v9, v49, v49
  v_dot2c_f32_bf16 v8, s70, v50
  v_dot2c_f32_bf16 v9, v50, v50
  v_dot2c_f32_bf16 v8, s70, v51
  v_dot2c_f32_bf16 v9, v51, v51
  s_waitcnt vmcnt(13)
  v_dot2c_f32_bf16 v6, s70, v20
  v_dot2c_f32_bf16 v7, v20, v20
  v_dot2c_f32_bf16 v6, s70, v21
  v_dot2c_f32_bf16 v7, v21, v21
  v_dot2c_f32_bf16 v6, s70, v22
  v_dot2c_f32_bf16 v7, v22, v22
  v_dot2c_f32_bf16 v6, s70, v23
  v_dot2c_f32_bf16 v7, v23, v23
  s_waitcnt vmcnt(12)
  v_dot2c_f32_bf16 v8, s70, v52
  v_dot2c_f32_bf16 v9, v52, v52
  v_dot2c_f32_bf16 v8, s70, v53
  v_dot2c_f32_bf16 v9, v53, v53
  v_dot2c_f32_bf16 v8, s70, v54
  v_dot2c_f32_bf16 v9, v54, v54
  v_dot2c_f32_bf16 v8, s70, v55
  v_dot2c_f32_bf16 v9, v55, v55
  s_waitcnt vmcnt(11)
  v_dot2c_f32_bf16 v6, s70, v24
  v_dot2c_f32_bf16 v7, v24, v24
  v_dot2c_f32_bf16 v6, s70, v25
  v_dot2c_f32_bf16 v7, v25, v25
  v_dot2c_f32_bf16 v6, s70, v26
  v_dot2c_f32_bf16 v7, v26, v26
  v_dot2c_f32_bf16 v6, s70, v27
  v_dot2c_f32_bf16 v7, v27, v27
  s_waitcnt vmcnt(10)
  v_dot2c_f32_bf16 v8, s70, v56
  v_dot2c_f32_bf16 v9, v56, v56
  v_dot2c_f32_bf16 v8, s70, v57
  v_dot2c_f32_bf16 v9, v57, v57
  v_dot2c_f32_bf16 v8, s70, v58
  v_dot2c_f32_bf16 v9, v58, v58
  v_dot2c_f32_bf16 v8, s70, v59
  v_dot2c_f32_bf16 v9, v59, v59
  s_waitcnt vmcnt(9)
  v_dot2c_f32_bf16 v6, s70, v28
  v_dot2c_f32_bf16 v7, v28, v28
  v_dot2c_f32_bf16 v6, s70, v29
  v_dot2c_f32_bf16 v7, v29, v29
  v_dot2c_f32_bf16 v6, s70, v30
  v_dot2c_f32_bf16 v7, v30, v30
  v_dot2c_f32_bf16 v6, s70, v31
  v_dot2c_f32_bf16 v7, v31, v31
  s_waitcnt vmcnt(8)
  v_dot2c_f32_bf16 v8, s70, v60
  v_dot2c_f32_bf16 v9, v60, v60
  v_dot2c_f32_bf16 v8, s70, v61
  v_dot2c_f32_bf16 v9, v61, v61
  v_dot2c_f32_bf16 v8, s70, v62
  v_dot2c_f32_bf16 v9, v62, v62
  v_dot2c_f32_bf16 v8, s70, v63
  v_dot2c_f32_bf16 v9, v63, v63
  s_waitcnt vmcnt(7)
  v_dot2c_f32_bf16 v6, s70, v32
  v_dot2c_f32_bf16 v7, v32, v32
  v_dot2c_f32_bf16 v6, s70, v33
  v_dot2c_f32_bf16 v7, v33, v33
  v_dot2c_f32_bf16 v6, s70, v34
  v_dot2c_f32_bf16 v7, v34, v34
  v_dot2c_f32_bf16 v6, s70, v35
  v_dot2c_f32_bf16 v7, v35, v35
  s_waitcnt vmcnt(6)
  v_dot2c_f32_bf16 v8, s70, v64
  v_dot2c_f32_bf16 v9, v64, v64
  v_dot2c_f32_bf16 v8, s70, v65
  v_dot2c_f32_bf16 v9, v65, v65
  v_dot2c_f32_bf16 v8, s70, v66
  v_dot2c_f32_bf16 v9, v66, v66
  v_dot2c_f32_bf16 v8, s70, v67
  v_dot2c_f32_bf16 v9, v67, v67
  s_waitcnt vmcnt(5)
  v_dot2c_f32_bf16 v6, s70, v36
  v_dot2c_f32_bf16 v7, v36, v36
  v_dot2c_f32_bf16 v6, s70, v37
  v_dot2c_f32_bf16 v7, v37, v37
  v_dot2c_f32_bf16 v6, s70, v38
  v_dot2c_f32_bf16 v7, v38, v38
  v_dot2c_f32_bf16 v6, s70, v39
  v_dot2c_f32_bf16 v7, v39, v39
  s_waitcnt vmcnt(4)
  v_dot2c_f32_bf16 v8, s70, v68
  v_dot2c_f32_bf16 v9, v68, v68
  v_dot2c_f32_bf16 v8, s70, v69
  v_dot2c_f32_bf16 v9, v69, v69
  v_dot2c_f32_bf16 v8, s70, v70
  v_dot2c_f32_bf16 v9, v70, v70
  v_dot2c_f32_bf16 v8, s70, v71
  v_dot2c_f32_bf16 v9, v71, v71
  s_waitcnt vmcnt(3)
  v_dot2c_f32_bf16 v6, s70, v40
  v_dot2c_f32_bf16 v7, v40, v40
  v_dot2c_f32_bf16 v6, s70, v41
  v_dot2c_f32_bf16 v7, v41, v41
  v_dot2c_f32_bf16 v6, s70, v42
  v_dot2c_f32_bf16 v7, v42, v42
  v_dot2c_f32_bf16 v6, s70, v43
  v_dot2c_f32_bf16 v7, v43, v43
  s_waitcnt vmcnt(2)
  v_dot2c_f32_bf16 v8, s70, v72
  v_dot2c_f32_bf16 v9, v72, v72
  v_dot2c_f32_bf16 v8, s70, v73
  v_dot2c_f32_bf16 v9, v73, v73
  v_dot2c_f32_bf16 v8, s70, v74
  v_dot2c_f32_bf16 v9, v74, v74
  v_dot2c_f32_bf16 v8, s70, v75
  v_dot2c_f32_bf16 v9, v75, v75
  s_waitcnt vmcnt(1)
  v_dot2c_f32_bf16 v6, s70, v44
  v_dot2c_f32_bf16 v7, v44, v44
  v_dot2c_f32_bf16 v6, s70, v45
  v_dot2c_f32_bf16 v7, v45, v45
  v_dot2c_f32_bf16 v6, s70, v46
  v_dot2c_f32_bf16 v7, v46, v46
  v_dot2c_f32_bf16 v6, s70, v47
  v_dot2c_f32_bf16 v7, v47, v47
  s_waitcnt vmcnt(0)
  v_dot2c_f32_bf16 v8, s70, v76
  v_dot2c_f32_bf16 v9, v76, v76
  v_dot2c_f32_bf16 v8, s70, v77
  v_dot2c_f32_bf16 v9, v77, v77
  v_dot2c_f32_bf16 v8, s70, v78
  v_dot2c_f32_bf16 v9, v78, v78
  v_dot2c_f32_bf16 v8, s70, v79
  v_dot2c_f32_bf16 v9, v79, v79
  s_nop 0
  v_add_f32_dpp v6, v6, v6 quad_perm:[1,0,3,2] row_mask:0xf bank_mask:0xf
  v_add_f32_dpp v7, v7, v7 quad_perm:[1,0,3,2] row_mask:0xf bank_mask:0xf
  v_add_f32_dpp v8, v8, v8 quad_perm:[1,0,3,2] row_mask:0xf bank_mask:0xf
  v_add_f32_dpp v9, v9, v9 quad_perm:[1,0,3,2] row_mask:0xf bank_mask:0xf
  v_add_f32_dpp v6, v6, v6 quad_perm:[2,3,0,1] row_mask:0xf bank_mask:0xf
  v_add_f32_dpp v7, v7, v7 quad_perm:[2,3,0,1] row_mask:0xf bank_mask:0xf
  v_add_f32_dpp v8, v8, v8 quad_perm:[2,3,0,1] row_mask:0xf bank_mask:0xf
  v_add_f32_dpp v9, v9, v9 quad_perm:[2,3,0,1] row_mask:0xf bank_mask:0xf
  v_add_f32_dpp v6, v6, v6 row_half_mirror row_mask:0xf bank_mask:0xf
  v_add_f32_dpp v7, v7, v7 row_half_mirror row_mask:0xf bank_mask:0xf
  v_add_f32_dpp v8, v8, v8 row_half_mirror row_mask:0xf bank_mask:0xf
  v_add_f32_dpp v9, v9, v9 row_half_mirror row_mask:0xf bank_mask:0xf
  v_mul_f32 v6, 0x3b000000, v6
  v_mul_f32 v7, 0x3b000000, v7
  v_mul_f32 v8, 0x3b000000, v8
  v_mul_f32 v9, 0x3b000000, v9
  v_fma_f32 v7, -v6, v6, v7
  v_fma_f32 v9, -v8, v8, v9
  v_max_f32 v7, 0, v7
  v_max_f32 v9, 0, v9
  v_cvt_pk_bf16_f32 v7, v6, v7
  v_cvt_pk_bf16_f32 v9, v8, v9
  v_lshlrev_b32 v6, 16, v7
  v_and_b32 v7, s71, v7
  v_lshlrev_b32 v8, 16, v9
  v_and_b32 v9, s71, v9
  v_add_f32 v7, 0x3727c5ac, v7
  v_add_f32 v9, 0x3727c5ac, v9
  v_cvt_pk_bf16_f32 v7, v7, v9
  v_and_b32 v9, s71, v7
  v_lshlrev_b32 v7, 16, v7
  v_sqrt_f32 v7, v7
  v_sqrt_f32 v9, v9
  s_nop 0
  v_cvt_pk_bf16_f32 v7, v7, v9
  v_and_b32 v9, s71, v7
  v_lshlrev_b32 v7, 16, v7
  v_rcp_f32 v10, v7
  v_rcp_f32 v12, v9
  s_nop 0
  v_mul_f32 v11, v6, v10
  v_mul_f32 v13, v8, v12
  v_lshlrev_b32 v80, 16, v16
  v_and_b32 v81, s71, v16
  v_lshlrev_b32 v82, 16, v17
  v_and_b32 v83, s71, v17
  v_lshlrev_b32 v84, 16, v18
  v_and_b32 v85, s71, v18
  v_lshlrev_b32 v86, 16, v19
  v_and_b32 v87, s71, v19
  v_pk_fma_f32 v[80:81], v[80:81], v[10:11], v[10:11] op_sel:[0,0,1] op_sel_hi:[1,0,1] neg_lo:[0,0,1] neg_hi:[0,0,1]
  v_pk_fma_f32 v[82:83], v[82:83], v[10:11], v[10:11] op_sel:[0,0,1] op_sel_hi:[1,0,1] neg_lo:[0,0,1] neg_hi:[0,0,1]
  v_pk_fma_f32 v[84:85], v[84:85], v[10:11], v[10:11] op_sel:[0,0,1] op_sel_hi:[1,0,1] neg_lo:[0,0,1] neg_hi:[0,0,1]
  v_pk_fma_f32 v[86:87], v[86:87], v[10:11], v[10:11] op_sel:[0,0,1] op_sel_hi:[1,0,1] neg_lo:[0,0,1] neg_hi:[0,0,1]
  v_cvt_pk_bf16_f32 v16, v80, v81
  v_cvt_pk_bf16_f32 v17, v82, v83
  v_cvt_pk_bf16_f32 v18, v84, v85
  v_cvt_pk_bf16_f32 v19, v86, v87
  ds_write_b128 v5, v[16:19] offset:0
  v_lshlrev_b32 v80, 16, v48
  v_and_b32 v81, s71, v48
  v_lshlrev_b32 v82, 16, v49
  v_and_b32 v83, s71, v49
  v_lshlrev_b32 v84, 16, v50
  v_and_b32 v85, s71, v50
  v_lshlrev_b32 v86, 16, v51
  v_and_b32 v87, s71, v51
  v_pk_fma_f32 v[80:81], v[80:81], v[12:13], v[12:13] op_sel:[0,0,1] op_sel_hi:[1,0,1] neg_lo:[0,0,1] neg_hi:[0,0,1]
  v_pk_fma_f32 v[82:83], v[82:83], v[12:13], v[12:13] op_sel:[0,0,1] op_sel_hi:[1,0,1] neg_lo:[0,0,1] neg_hi:[0,0,1]
  v_pk_fma_f32 v[84:85], v[84:85], v[12:13], v[12:13] op_sel:[0,0,1] op_sel_hi:[1,0,1] neg_lo:[0,0,1] neg_hi:[0,0,1]
  v_pk_fma_f32 v[86:87], v[86:87], v[12:13], v[12:13] op_sel:[0,0,1] op_sel_hi:[1,0,1] neg_lo:[0,0,1] neg_hi:[0,0,1]
  v_cvt_pk_bf16_f32 v48, v80, v81
  v_cvt_pk_bf16_f32 v49, v82, v83
  v_cvt_pk_bf16_f32 v50, v84, v85
  v_cvt_pk_bf16_f32 v51, v86, v87
  ds_write_b128 v5, v[48:51] offset:128
  v_lshlrev_b32 v80, 16, v20
  v_and_b32 v81, s71, v20
  v_lshlrev_b32 v82, 16, v21
  v_and_b32 v83, s71, v21
  v_lshlrev_b32 v84, 16, v22
  v_and_b32 v85, s71, v22
  v_lshlrev_b32 v86, 16, v23
  v_and_b32 v87, s71, v23
  v_pk_fma_f32 v[80:81], v[80:81], v[10:11], v[10:11] op_sel:[0,0,1] op_sel_hi:[1,0,1] neg_lo:[0,0,1] neg_hi:[0,0,1]
  v_pk_fma_f32 v[82:83], v[82:83], v[10:11], v[10:11] op_sel:[0,0,1] op_sel_hi:[1,0,1] neg_lo:[0,0,1] neg_hi:[0,0,1]
  v_pk_fma_f32 v[84:85], v[84:85], v[10:11], v[10:11] op_sel:[0,0,1] op_sel_hi:[1,0,1] neg_lo:[0,0,1] neg_hi:[0,0,1]
  v_pk_fma_f32 v[86:87], v[86:87], v[10:11], v[10:11] op_sel:[0,0,1] op_sel_hi:[1,0,1] neg_lo:[0,0,1] neg_hi:[0,0,1]
  v_cvt_pk_bf16_f32 v20, v80, v81
  v_cvt_pk_bf16_f32 v21, v82, v83
  v_cvt_pk_bf16_f32 v22, v84, v85
  v_cvt_pk_bf16_f32 v23, v86, v87
  ds_write_b128 v5, v[20:23] offset:4096
  v_lshlrev_b32 v80, 16, v52
  v_and_b32 v81, s71, v52
  v_lshlrev_b32 v82, 16, v53
  v_and_b32 v83, s71, v53
  v_lshlrev_b32 v84, 16, v54
  v_and_b32 v85, s71, v54
  v_lshlrev_b32 v86, 16, v55
  v_and_b32 v87, s71, v55
  v_pk_fma_f32 v[80:81], v[80:81], v[12:13], v[12:13] op_sel:[0,0,1] op_sel_hi:[1,0,1] neg_lo:[0,0,1] neg_hi:[0,0,1]
  v_pk_fma_f32 v[82:83], v[82:83], v[12:13], v[12:13] op_sel:[0,0,1] op_sel_hi:[1,0,1] neg_lo:[0,0,1] neg_hi:[0,0,1]
  v_pk_fma_f32 v[84:85], v[84:85], v[12:13], v[12:13] op_sel:[0,0,1] op_sel_hi:[1,0,1] neg_lo:[0,0,1] neg_hi:[0,0,1]
  v_pk_fma_f32 v[86:87], v[86:87], v[12:13], v[12:13] op_sel:[0,0,1] op_sel_hi:[1,0,1] neg_lo:[0,0,1] neg_hi:[0,0,1]
  v_cvt_pk_bf16_f32 v52, v80, v81
  v_cvt_pk_bf16_f32 v53, v82, v83
  v_cvt_pk_bf16_f32 v54, v84, v85
  v_cvt_pk_bf16_f32 v55, v86, v87
  ds_write_b128 v5, v[52:55] offset:4224
  v_lshlrev_b32 v80, 16, v24
  v_and_b32 v81, s71, v24
  v_lshlrev_b32 v82, 16, v25
  v_and_b32 v83, s71, v25
  v_lshlrev_b32 v84, 16, v26
  v_and_b32 v85, s71, v26
  v_lshlrev_b32 v86, 16, v27
  v_and_b32 v87, s71, v27
  v_pk_fma_f32 v[80:81], v[80:81], v[10:11], v[10:11] op_sel:[0,0,1] op_sel_hi:[1,0,1] neg_lo:[0,0,1] neg_hi:[0,0,1]
  v_pk_fma_f32 v[82:83], v[82:83], v[10:11], v[10:11] op_sel:[0,0,1] op_sel_hi:[1,0,1] neg_lo:[0,0,1] neg_hi:[0,0,1]
  v_pk_fma_f32 v[84:85], v[84:85], v[10:11], v[10:11] op_sel:[0,0,1] op_sel_hi:[1,0,1] neg_lo:[0,0,1] neg_hi:[0,0,1]
  v_pk_fma_f32 v[86:87], v[86:87], v[10:11], v[10:11] op_sel:[0,0,1] op_sel_hi:[1,0,1] neg_lo:[0,0,1] neg_hi:[0,0,1]
  v_cvt_pk_bf16_f32 v24, v80, v81
  v_cvt_pk_bf16_f32 v25, v82, v83
  v_cvt_pk_bf16_f32 v26, v84, v85
  v_cvt_pk_bf16_f32 v27, v86, v87
  ds_write_b128 v5, v[24:27] offset:8192
  v_lshlrev_b32 v80, 16, v56
  v_and_b32 v81, s71, v56
  v_lshlrev_b32 v82, 16, v57
  v_and_b32 v83, s71, v57
  v_lshlrev_b32 v84, 16, v58
  v_and_b32 v85, s71, v58
  v_lshlrev_b32 v86, 16, v59
  v_and_b32 v87, s71, v59
  v_pk_fma_f32 v[80:81], v[80:81], v[12:13], v[12:13] op_sel:[0,0,1] op_sel_hi:[1,0,1] neg_lo:[0,0,1] neg_hi:[0,0,1]
  v_pk_fma_f32 v[82:83], v[82:83], v[12:13], v[12:13] op_sel:[0,0,1] op_sel_hi:[1,0,1] neg_lo:[0,0,1] neg_hi:[0,0,1]
  v_pk_fma_f32 v[84:85], v[84:85], v[12:13], v[12:13] op_sel:[0,0,1] op_sel_hi:[1,0,1] neg_lo:[0,0,1] neg_hi:[0,0,1]
  v_pk_fma_f32 v[86:87], v[86:87], v[12:13], v[12:13] op_sel:[0,0,1] op_sel_hi:[1,0,1] neg_lo:[0,0,1] neg_hi:[0,0,1]
  v_cvt_pk_bf16_f32 v56, v80, v81
  v_cvt_pk_bf16_f32 v57, v82, v83
  v_cvt_pk_bf16_f32 v58, v84, v85
  v_cvt_pk_bf16_f32 v59, v86, v87
  ds_write_b128 v5, v[56:59] offset:8320
  v_lshlrev_b32 v80, 16, v28
  v_and_b32 v81, s71, v28
  v_lshlrev_b32 v82, 16, v29
  v_and_b32 v83, s71, v29
  v_lshlrev_b32 v84, 16, v30
  v_and_b32 v85, s71, v30
  v_lshlrev_b32 v86, 16, v31
  v_and_b32 v87, s71, v31
  v_pk_fma_f32 v[80:81], v[80:81], v[10:11], v[10:11] op_sel:[0,0,1] op_sel_hi:[1,0,1] neg_lo:[0,0,1] neg_hi:[0,0,1]
  v_pk_fma_f32 v[82:83], v[82:83], v[10:11], v[10:11] op_sel:[0,0,1] op_sel_hi:[1,0,1] neg_lo:[0,0,1] neg_hi:[0,0,1]
  v_pk_fma_f32 v[84:85], v[84:85], v[10:11], v[10:11] op_sel:[0,0,1] op_sel_hi:[1,0,1] neg_lo:[0,0,1] neg_hi:[0,0,1]
  v_pk_fma_f32 v[86:87], v[86:87], v[10:11], v[10:11] op_sel:[0,0,1] op_sel_hi:[1,0,1] neg_lo:[0,0,1] neg_hi:[0,0,1]
  v_cvt_pk_bf16_f32 v28, v80, v81
  v_cvt_pk_bf16_f32 v29, v82, v83
  v_cvt_pk_bf16_f32 v30, v84, v85
  v_cvt_pk_bf16_f32 v31, v86, v87
  ds_write_b128 v5, v[28:31] offset:12288
  v_lshlrev_b32 v80, 16, v60
  v_and_b32 v81, s71, v60
  v_lshlrev_b32 v82, 16, v61
  v_and_b32 v83, s71, v61
  v_lshlrev_b32 v84, 16, v62
  v_and_b32 v85, s71, v62
  v_lshlrev_b32 v86, 16, v63
  v_and_b32 v87, s71, v63
  v_pk_fma_f32 v[80:81], v[80:81], v[12:13], v[12:13] op_sel:[0,0,1] op_sel_hi:[1,0,1] neg_lo:[0,0,1] neg_hi:[0,0,1]
  v_pk_fma_f32 v[82:83], v[82:83], v[12:13], v[12:13] op_sel:[0,0,1] op_sel_hi:[1,0,1] neg_lo:[0,0,1] neg_hi:[0,0,1]
  v_pk_fma_f32 v[84:85], v[84:85], v[12:13], v[12:13] op_sel:[0,0,1] op_sel_hi:[1,0,1] neg_lo:[0,0,1] neg_hi:[0,0,1]
  v_pk_fma_f32 v[86:87], v[86:87], v[12:13], v[12:13] op_sel:[0,0,1] op_sel_hi:[1,0,1] neg_lo:[0,0,1] neg_hi:[0,0,1]
  v_cvt_pk_bf16_f32 v60, v80, v81
  v_cvt_pk_bf16_f32 v61, v82, v83
  v_cvt_pk_bf16_f32 v62, v84, v85
  v_cvt_pk_bf16_f32 v63, v86, v87
  ds_write_b128 v5, v[60:63] offset:12416
  v_lshlrev_b32 v80, 16, v32
  v_and_b32 v81, s71, v32
  v_lshlrev_b32 v82, 16, v33
  v_and_b32 v83, s71, v33
  v_lshlrev_b32 v84, 16, v34
  v_and_b32 v85, s71, v34
  v_lshlrev_b32 v86, 16, v35
  v_and_b32 v87, s71, v35
  v_pk_fma_f32 v[80:81], v[80:81], v[10:11], v[10:11] op_sel:[0,0,1] op_sel_hi:[1,0,1] neg_lo:[0,0,1] neg_hi:[0,0,1]
  v_pk_fma_f32 v[82:83], v[82:83], v[10:11], v[10:11] op_sel:[0,0,1] op_sel_hi:[1,0,1] neg_lo:[0,0,1] neg_hi:[0,0,1]
  v_pk_fma_f32 v[84:85], v[84:85], v[10:11], v[10:11] op_sel:[0,0,1] op_sel_hi:[1,0,1] neg_lo:[0,0,1] neg_hi:[0,0,1]
  v_pk_fma_f32 v[86:87], v[86:87], v[10:11], v[10:11] op_sel:[0,0,1] op_sel_hi:[1,0,1] neg_lo:[0,0,1] neg_hi:[0,0,1]
  v_cvt_pk_bf16_f32 v32, v80, v81
  v_cvt_pk_bf16_f32 v33, v82, v83
  v_cvt_pk_bf16_f32 v34, v84, v85
  v_cvt_pk_bf16_f32 v35, v86, v87
  ds_write_b128 v5, v[32:35] offset:16384
  v_lshlrev_b32 v80, 16, v64
  v_and_b32 v81, s71, v64
  v_lshlrev_b32 v82, 16, v65
  v_and_b32 v83, s71, v65
  v_lshlrev_b32 v84, 16, v66
  v_and_b32 v85, s71, v66
  v_lshlrev_b32 v86, 16, v67
  v_and_b32 v87, s71, v67
  v_pk_fma_f32 v[80:81], v[80:81], v[12:13], v[12:13] op_sel:[0,0,1] op_sel_hi:[1,0,1] neg_lo:[0,0,1] neg_hi:[0,0,1]
  v_pk_fma_f32 v[82:83], v[82:83], v[12:13], v[12:13] op_sel:[0,0,1] op_sel_hi:[1,0,1] neg_lo:[0,0,1] neg_hi:[0,0,1]
  v_pk_fma_f32 v[84:85], v[84:85], v[12:13], v[12:13] op_sel:[0,0,1] op_sel_hi:[1,0,1] neg_lo:[0,0,1] neg_hi:[0,0,1]
  v_pk_fma_f32 v[86:87], v[86:87], v[12:13], v[12:13] op_sel:[0,0,1] op_sel_hi:[1,0,1] neg_lo:[0,0,1] neg_hi:[0,0,1]
  v_cvt_pk_bf16_f32 v64, v80, v81
  v_cvt_pk_bf16_f32 v65, v82, v83
  v_cvt_pk_bf16_f32 v66, v84, v85
  v_cvt_pk_bf16_f32 v67, v86, v87
  ds_write_b128 v5, v[64:67] offset:16512
  v_lshlrev_b32 v80, 16, v36
  v_and_b32 v81, s71, v36
  v_lshlrev_b32 v82, 16, v37
  v_and_b32 v83, s71, v37
  v_lshlrev_b32 v84, 16, v38
  v_and_b32 v85, s71, v38
  v_lshlrev_b32 v86, 16, v39
  v_and_b32 v87, s71, v39
  v_pk_fma_f32 v[80:81], v[80:81], v[10:11], v[10:11] op_sel:[0,0,1] op_sel_hi:[1,0,1] neg_lo:[0,0,1] neg_hi:[0,0,1]
  v_pk_fma_f32 v[82:83], v[82:83], v[10:11], v[10:11] op_sel:[0,0,1] op_sel_hi:[1,0,1] neg_lo:[0,0,1] neg_hi:[0,0,1]
  v_pk_fma_f32 v[84:85], v[84:85], v[10:11], v[10:11] op_sel:[0,0,1] op_sel_hi:[1,0,1] neg_lo:[0,0,1] neg_hi:[0,0,1]
  v_pk_fma_f32 v[86:87], v[86:87], v[10:11], v[10:11] op_sel:[0,0,1] op_sel_hi:[1,0,1] neg_lo:[0,0,1] neg_hi:[0,0,1]
  v_cvt_pk_bf16_f32 v36, v80, v81
  v_cvt_pk_bf16_f32 v37, v82, v83
  v_cvt_pk_bf16_f32 v38, v84, v85
  v_cvt_pk_bf16_f32 v39, v86, v87
  ds_write_b128 v5, v[36:39] offset:20480
  v_lshlrev_b32 v80, 16, v68
  v_and_b32 v81, s71, v68
  v_lshlrev_b32 v82, 16, v69
  v_and_b32 v83, s71, v69
  v_lshlrev_b32 v84, 16, v70
  v_and_b32 v85, s71, v70
  v_lshlrev_b32 v86, 16, v71
  v_and_b32 v87, s71, v71
  v_pk_fma_f32 v[80:81], v[80:81], v[12:13], v[12:13] op_sel:[0,0,1] op_sel_hi:[1,0,1] neg_lo:[0,0,1] neg_hi:[0,0,1]
  v_pk_fma_f32 v[82:83], v[82:83], v[12:13], v[12:13] op_sel:[0,0,1] op_sel_hi:[1,0,1] neg_lo:[0,0,1] neg_hi:[0,0,1]
  v_pk_fma_f32 v[84:85], v[84:85], v[12:13], v[12:13] op_sel:[0,0,1] op_sel_hi:[1,0,1] neg_lo:[0,0,1] neg_hi:[0,0,1]
  v_pk_fma_f32 v[86:87], v[86:87], v[12:13], v[12:13] op_sel:[0,0,1] op_sel_hi:[1,0,1] neg_lo:[0,0,1] neg_hi:[0,0,1]
  v_cvt_pk_bf16_f32 v68, v80, v81
  v_cvt_pk_bf16_f32 v69, v82, v83
  v_cvt_pk_bf16_f32 v70, v84, v85
  v_cvt_pk_bf16_f32 v71, v86, v87
  ds_write_b128 v5, v[68:71] offset:20608
  v_lshlrev_b32 v80, 16, v40
  v_and_b32 v81, s71, v40
  v_lshlrev_b32 v82, 16, v41
  v_and_b32 v83, s71, v41
  v_lshlrev_b32 v84, 16, v42
  v_and_b32 v85, s71, v42
  v_lshlrev_b32 v86, 16, v43
  v_and_b32 v87, s71, v43
  v_pk_fma_f32 v[80:81], v[80:81], v[10:11], v[10:11] op_sel:[0,0,1] op_sel_hi:[1,0,1] neg_lo:[0,0,1] neg_hi:[0,0,1]
  v_pk_fma_f32 v[82:83], v[82:83], v[10:11], v[10:11] op_sel:[0,0,1] op_sel_hi:[1,0,1] neg_lo:[0,0,1] neg_hi:[0,0,1]
  v_pk_fma_f32 v[84:85], v[84:85], v[10:11], v[10:11] op_sel:[0,0,1] op_sel_hi:[1,0,1] neg_lo:[0,0,1] neg_hi:[0,0,1]
  v_pk_fma_f32 v[86:87], v[86:87], v[10:11], v[10:11] op_sel:[0,0,1] op_sel_hi:[1,0,1] neg_lo:[0,0,1] neg_hi:[0,0,1]
  v_cvt_pk_bf16_f32 v40, v80, v81
  v_cvt_pk_bf16_f32 v41, v82, v83
  v_cvt_pk_bf16_f32 v42, v84, v85
  v_cvt_pk_bf16_f32 v43, v86, v87
  ds_write_b128 v5, v[40:43] offset:24576
  v_lshlrev_b32 v80, 16, v72
  v_and_b32 v81, s71, v72
  v_lshlrev_b32 v82, 16, v73
  v_and_b32 v83, s71, v73
  v_lshlrev_b32 v84, 16, v74
  v_and_b32 v85, s71, v74
  v_lshlrev_b32 v86, 16, v75
  v_and_b32 v87, s71, v75
  v_pk_fma_f32 v[80:81], v[80:81], v[12:13], v[12:13] op_sel:[0,0,1] op_sel_hi:[1,0,1] neg_lo:[0,0,1] neg_hi:[0,0,1]
  v_pk_fma_f32 v[82:83], v[82:83], v[12:13], v[12:13] op_sel:[0,0,1] op_sel_hi:[1,0,1] neg_lo:[0,0,1] neg_hi:[0,0,1]
  v_pk_fma_f32 v[84:85], v[84:85], v[12:13], v[12:13] op_sel:[0,0,1] op_sel_hi:[1,0,1] neg_lo:[0,0,1] neg_hi:[0,0,1]
  v_pk_fma_f32 v[86:87], v[86:87], v[12:13], v[12:13] op_sel:[0,0,1] op_sel_hi:[1,0,1] neg_lo:[0,0,1] neg_hi:[0,0,1]
  v_cvt_pk_bf16_f32 v72, v80, v81
  v_cvt_pk_bf16_f32 v73, v82, v83
  v_cvt_pk_bf16_f32 v74, v84, v85
  v_cvt_pk_bf16_f32 v75, v86, v87
  ds_write_b128 v5, v[72:75] offset:24704
  v_lshlrev_b32 v80, 16, v44
  v_and_b32 v81, s71, v44
  v_lshlrev_b32 v82, 16, v45
  v_and_b32 v83, s71, v45
  v_lshlrev_b32 v84, 16, v46
  v_and_b32 v85, s71, v46
  v_lshlrev_b32 v86, 16, v47
  v_and_b32 v87, s71, v47
  v_pk_fma_f32 v[80:81], v[80:81], v[10:11], v[10:11] op_sel:[0,0,1] op_sel_hi:[1,0,1] neg_lo:[0,0,1] neg_hi:[0,0,1]
  v_pk_fma_f32 v[82:83], v[82:83], v[10:11], v[10:11] op_sel:[0,0,1] op_sel_hi:[1,0,1] neg_lo:[0,0,1] neg_hi:[0,0,1]
  v_pk_fma_f32 v[84:85], v[84:85], v[10:11], v[10:11] op_sel:[0,0,1] op_sel_hi:[1,0,1] neg_lo:[0,0,1] neg_hi:[0,0,1]
  v_pk_fma_f32 v[86:87], v[86:87], v[10:11], v[10:11] op_sel:[0,0,1] op_sel_hi:[1,0,1] neg_lo:[0,0,1] neg_hi:[0,0,1]
  v_cvt_pk_bf16_f32 v44, v80, v81
  v_cvt_pk_bf16_f32 v45, v82, v83
  v_cvt_pk_bf16_f32 v46, v84, v85
  v_cvt_pk_bf16_f32 v47, v86, v87
  ds_write_b128 v5, v[44:47] offset:28672
  v_lshlrev_b32 v80, 16, v76
  v_and_b32 v81, s71, v76
  v_lshlrev_b32 v82, 16, v77
  v_and_b32 v83, s71, v77
  v_lshlrev_b32 v84, 16, v78
  v_and_b32 v85, s71, v78
  v_lshlrev_b32 v86, 16, v79
  v_and_b32 v87, s71, v79
  v_pk_fma_f32 v[80:81], v[80:81], v[12:13], v[12:13] op_sel:[0,0,1] op_sel_hi:[1,0,1] neg_lo:[0,0,1] neg_hi:[0,0,1]
  v_pk_fma_f32 v[82:83], v[82:83], v[12:13], v[12:13] op_sel:[0,0,1] op_sel_hi:[1,0,1] neg_lo:[0,0,1] neg_hi:[0,0,1]
  v_pk_fma_f32 v[84:85], v[84:85], v[12:13], v[12:13] op_sel:[0,0,1] op_sel_hi:[1,0,1] neg_lo:[0,0,1] neg_hi:[0,0,1]
  v_pk_fma_f32 v[86:87], v[86:87], v[12:13], v[12:13] op_sel:[0,0,1] op_sel_hi:[1,0,1] neg_lo:[0,0,1] neg_hi:[0,0,1]
  v_cvt_pk_bf16_f32 v76, v80, v81
  v_cvt_pk_bf16_f32 v77, v82, v83
  v_cvt_pk_bf16_f32 v78, v84, v85
  v_cvt_pk_bf16_f32 v79, v86, v87
  ds_write_b128 v5, v[76:79] offset:28800
  s_waitcnt lgkmcnt(0)
  s_barrier
  s_mul_i32 s75, s75, 0x19660d
  s_add_u32 s75, s75, 0x3c6ef35f
  s_xor_b32 s67, s21, 2
  s_mul_i32 s67, s67, 0x30000
  s_add_u32 m0, s73, 0xc000
  s_nop 0
  buffer_load_dwordx4 v96, s[28:31], s67 offen lds
  buffer_load_dwordx4 v97, s[28:31], s67 offen offset:1024 lds
  s_add_u32 m0, s73, 0xc800
  s_nop 0
  buffer_load_dwordx4 v98, s[28:31], s67 offen lds
  buffer_load_dwordx4 v99, s[28:31], s67 offen offset:1024 lds
  s_add_u32 m0, s73, 0xd000
  s_nop 0
  buffer_load_dwordx4 v100, s[28:31], s67 offen lds
  buffer_load_dwordx4 v101, s[28:31], s67 offen offset:1024 lds
  s_barrier
  s_xor_b32 s67, s21, 3
  s_mul_i32 s67, s67, 0x30000
  s_add_u32 m0, s73, 0x12000
  s_nop 0
  buffer_load_dwordx4 v96, s[28:31], s67 offen lds
  buffer_load_dwordx4 v97, s[28:31], s67 offen offset:1024 lds
  s_add_u32 m0, s73, 0x12800
  s_nop 0
  buffer_load_dwordx4 v98, s[28:31], s67 offen lds
  buffer_load_dwordx4 v99, s[28:31], s67 offen offset:1024 lds
  s_add_u32 m0, s73, 0x13000
  s_nop 0
  buffer_load_dwordx4 v100, s[28:31], s67 offen lds
  buffer_load_dwordx4 v101, s[28:31], s67 offen offset:1024 lds
  s_waitcnt vmcnt(6)
  s_barrier
  s_xor_b32 s67, s21, 4
  s_mul_i32 s67, s67, 0x30000
  s_add_u32 m0, s73, 0x0
  s_nop 0
  buffer_load_dwordx4 v96, s[28:31], s67 offen lds
  buffer_load_dwordx4 v97, s[28:31], s67 offen offset:1024 lds
  s_add_u32 m0, s73, 0x800
  s_nop 0
  buffer_load_dwordx4 v98, s[28:31], s67 offen lds
  buffer_load_dwordx4 v99, s[28:31], s67 offen offset:1024 lds
  s_add_u32 m0, s73, 0x1000
  s_nop 0
  buffer_load_dwordx4 v100, s[28:31], s67 offen lds
  buffer_load_dwordx4 v101, s[28:31], s67 offen offset:1024 lds
  v_lshlrev_b32 v2, 4, v0
  v_lshrrev_b32 v1, 5, v0
  v_and_b32 v3, 15, v0
  v_lshlrev_b32 v3, 4, v3
  v_lshl_add_u32 v3, v1, 8, v3
  s_lshl_b32 s71, s63, 6
  s_lshl4_add_u32 s68, s60, s71
  s_lshl_b32 s68, s68, 11
  s_add_u32 s68, s68, 0x300000
  s_add_u32 s56, s22, s68
  s_addc_u32 s57, s23, 0
  s_mov_b32 s58, 0x8000
  s_mov_b32 s59, 0x20000
  s_lshl3_add_u32 s70, s64, s71
  s_xor_b32 s68, s60, 3
  s_lshl1_add_u32 s68, s68, s70
  s_waitcnt vmcnt(6)
  s_barrier
  s_xor_b32 s67, s21, 5
  s_mul_i32 s67, s67, 0x30000
  s_add_u32 m0, s73, 0x6000
  s_nop 0
  buffer_load_dwordx4 v96, s[28:31], s67 offen lds
  buffer_load_dwordx4 v97, s[28:31], s67 offen offset:1024 lds
  s_add_u32 m0, s73, 0x6800
  s_nop 0
  buffer_load_dwordx4 v98, s[28:31], s67 offen lds
  buffer_load_dwordx4 v99, s[28:31], s67 offen offset:1024 lds
  s_add_u32 m0, s73, 0x7000
  s_nop 0
  buffer_load_dwordx4 v100, s[28:31], s67 offen lds
  buffer_load_dwordx4 v101, s[28:31], s67 offen offset:1024 lds
  s_lshl_b32 s12, s68, 10
  s_add_u32 s12, s12, 0x100000
  s_xor_b32 s68, s60, 2
  s_lshl1_add_u32 s68, s68, s70
  s_lshl_b32 s13, s68, 10
  s_add_u32 s13, s13, 0x100000
  s_xor_b32 s68, s60, 1
  s_lshl1_add_u32 s68, s68, s70
  s_lshl_b32 s14, s68, 10
  s_add_u32 s14, s14, 0x100000
  s_xor_b32 s68, s60, 0
  s_lshl1_add_u32 s68, s68, s70
  s_lshl_b32 s15, s68, 10
  s_add_u32 s15, s15, 0x100000
  s_lshl2_add_u32 s72, s64, s60
  s_lshl_b32 s72, s72, 1
  s_lshl_b32 s6, s72, 5
  s_add_u32 s6, s6, s63
  s_waitcnt vmcnt(6)
  s_barrier
  s_xor_b32 s67, s21, 6
  s_mul_i32 s67, s67, 0x30000
  s_add_u32 m0, s73, 0xc000
  s_nop 0
  buffer_load_dwordx4 v96, s[28:31], s67 offen lds
  buffer_load_dwordx4 v97, s[28:31], s67 offen offset:1024 lds
  s_add_u32 m0, s73, 0xc800
  s_nop 0
  buffer_load_dwordx4 v98, s[28:31], s67 offen lds
  buffer_load_dwordx4 v99, s[28:31], s67 offen offset:1024 lds
  s_add_u32 m0, s73, 0xd000
  s_nop 0
  buffer_load_dwordx4 v100, s[28:31], s67 offen lds
  buffer_load_dwordx4 v101, s[28:31], s67 offen offset:1024 lds
  s_lshl_b32 s6, s6, 10
  s_add_u32 s6, s6, 0x700000
  s_add_u32 s7, s6, 0x8000
  s_lshl4_add_u32 s8, s72, s63
  s_lshl_b32 s8, s8, 7
  s_add_u32 s8, s8, 0x80000
  s_lshr_b32 s9, s63, 2
  s_lshl_b32 s9, s9, 12
  s_add_u32 s9, s9, 0x40000
  v_and_b32 v124, 31, v0
  v_lshlrev_b32 v124, 7, v124
  s_mov_b32 s76, 0xffff
  s_mov_b32 s77, 0xffff
  v_and_b32 v1, 27, v0
  v_mov_b32 v126, 0x3f803f80
  v_cmp_eq_u32 vcc, 16, v1
  s_waitcnt vmcnt(6)
  s_barrier
  s_xor_b32 s67, s21, 7
  s_mul_i32 s67, s67, 0x30000
  s_add_u32 m0, s73, 0x12000
  s_nop 0
  buffer_load_dwordx4 v96, s[28:31], s67 offen lds
  buffer_load_dwordx4 v97, s[28:31], s67 offen offset:1024 lds
  s_add_u32 m0, s73, 0x12800
  s_nop 0
  buffer_load_dwordx4 v98, s[28:31], s67 offen lds
  buffer_load_dwordx4 v99, s[28:31], s67 offen offset:1024 lds
  s_add_u32 m0, s73, 0x13000
  s_nop 0
  buffer_load_dwordx4 v100, s[28:31], s67 offen lds
  buffer_load_dwordx4 v101, s[28:31], s67 offen offset:1024 lds
  s_mov_b32 s71, 0
  s_nop 0
  v_cndmask_b32 v1, 0, v126, vcc
  s_lshr_b32 s68, s10, 3
  s_lshl2_add_u32 s68, s3, s68
  s_lshl2_add_u32 s68, s68, s60
  s_lshl_b32 s68, s68, 14
  s_and_b32 s69, s10, 7
  s_lshl_b32 s69, s69, 7
  s_add_u32 s16, s68, s69
  s_add_u32 s17, s16, 0x1c00
  s_lshl_b32 s18, s60, 11
  s_add_u32 s18, s18, 0x10100
  s_lshl_b32 s68, s60, 2
  s_add_u32 s68, s68, 0x10000
  v_mov_b32 v14, s68
  v_mov_b32 v15, 0
  s_waitcnt vmcnt(6)
  s_barrier
  s_mov_b32 m0, s18
  s_nop 0
  buffer_load_dwordx4 v4, s[24:27], s16 offen lds
  buffer_load_dwordx4 v4, s[24:27], s17 offen offset:1024 lds
  s_waitcnt vmcnt(2)
  s_barrier
  ds_write_b32 v14, v15
  ds_write_b32 v14, v15 offset:16
  ds_write_b32 v14, v15 offset:32
  ds_write_b32 v14, v15 offset:48
  s_mov_b32 s67, 4
  s_waitcnt vmcnt(0) lgkmcnt(0)
  s_barrier
  s_barrier
  v_mov_b32 v80, v1
  v_mov_b32 v81, v1
  v_mov_b32 v82, v1
  v_mov_b32 v83, v1
  v_mov_b32 v84, v1
  v_mov_b32 v85, v1
  v_mov_b32 v86, v1
  v_mov_b32 v87, v1
  v_mov_b32 v92, v1
  v_mov_b32 v93, v1
  v_mov_b32 v94, v1
  v_mov_b32 v95, v1
  v_mov_b32 v96, v1
  v_mov_b32 v97, v1
  v_mov_b32 v98, v1
  v_mov_b32 v99, v1
  v_mov_b32 v104, v1
  v_mov_b32 v105, v1
  v_mov_b32 v106, v1
  v_mov_b32 v107, v1
  v_mov_b32 v108, v1
  v_mov_b32 v109, v1
  v_mov_b32 v110, v1
  v_mov_b32 v111, v1
  v_mov_b32 v116, v1
  v_mov_b32 v117, v1
  v_mov_b32 v118, v1
  v_mov_b32 v119, v1
  v_mov_b32 v120, v1
  v_mov_b32 v121, v1
  v_mov_b32 v122, v1
  v_mov_b32 v123, v1
  v_mov_b32 v128, 0
  v_mov_b32 v129, 0
  v_mov_b32 v130, 0
  v_mov_b32 v131, 0
  v_mov_b32 v132, 0
  v_mov_b32 v133, 0
  v_mov_b32 v134, 0
  v_mov_b32 v135, 0
  v_mov_b32 v136, 0
  v_mov_b32 v137, 0
  v_mov_b32 v138, 0
  v_mov_b32 v139, 0
  v_mov_b32 v140, 0
  v_mov_b32 v141, 0
  v_mov_b32 v142, 0
  v_mov_b32 v143, 0
  v_mov_b32 v144, 0
  v_mov_b32 v145, 0
  v_mov_b32 v146, 0
  v_mov_b32 v147, 0
  v_mov_b32 v148, 0
  v_mov_b32 v149, 0
  v_mov_b32 v150, 0
  v_mov_b32 v151, 0
  v_mov_b32 v152, 0
  v_mov_b32 v153, 0
  v_mov_b32 v154, 0
  v_mov_b32 v155, 0
  v_mov_b32 v156, 0
  v_mov_b32 v157, 0
  v_mov_b32 v158, 0
  v_mov_b32 v159, 0
  v_mov_b32 v160, 0
  v_mov_b32 v161, 0
  v_mov_b32 v162, 0
  v_mov_b32 v163, 0
  v_mov_b32 v164, 0
  v_mov_b32 v165, 0
  v_mov_b32 v166, 0
  v_mov_b32 v167, 0
  v_mov_b32 v168, 0
  v_mov_b32 v169, 0
  v_mov_b32 v170, 0
  v_mov_b32 v171, 0
  v_mov_b32 v172, 0
  v_mov_b32 v173, 0
  v_mov_b32 v174, 0
  v_mov_b32 v175, 0
  v_mov_b32 v176, 0
  v_mov_b32 v177, 0
  v_mov_b32 v178, 0
  v_mov_b32 v179, 0
  v_mov_b32 v180, 0
  v_mov_b32 v181, 0
  v_mov_b32 v182, 0
  v_mov_b32 v183, 0
  v_mov_b32 v184, 0
  v_mov_b32 v185, 0
  v_mov_b32 v186, 0
  v_mov_b32 v187, 0
  v_mov_b32 v188, 0
  v_mov_b32 v189, 0
  v_mov_b32 v190, 0
  v_mov_b32 v191, 0
  v_mov_b32 v192, 0
  v_mov_b32 v193, 0
  v_mov_b32 v194, 0
  v_mov_b32 v195, 0
  v_mov_b32 v196, 0
  v_mov_b32 v197, 0
  v_mov_b32 v198, 0
  v_mov_b32 v199, 0
  v_mov_b32 v200, 0
  v_mov_b32 v201, 0
  v_mov_b32 v202, 0
  v_mov_b32 v203, 0
  v_mov_b32 v204, 0
  v_mov_b32 v205, 0
  v_mov_b32 v206, 0
  v_mov_b32 v207, 0
  v_mov_b32 v208, 0
  v_mov_b32 v209, 0
  v_mov_b32 v210, 0
  v_mov_b32 v211, 0
  v_mov_b32 v212, 0
  v_mov_b32 v213, 0
  v_mov_b32 v214, 0
  v_mov_b32 v215, 0
  v_mov_b32 v216, 0
  v_mov_b32 v217, 0
  v_mov_b32 v218, 0
  v_mov_b32 v219, 0
  v_mov_b32 v220, 0
  v_mov_b32 v221, 0
  v_mov_b32 v222, 0
  v_mov_b32 v223, 0
  v_mov_b32 v224, 0
  v_mov_b32 v225, 0
  v_mov_b32 v226, 0
  v_mov_b32 v227, 0
  v_mov_b32 v228, 0
  v_mov_b32 v229, 0
  v_mov_b32 v230, 0
  v_mov_b32 v231, 0
  v_mov_b32 v232, 0
  v_mov_b32 v233, 0
  v_mov_b32 v234, 0
  v_mov_b32 v235, 0
  v_mov_b32 v236, 0
  v_mov_b32 v237, 0
  v_mov_b32 v238, 0
  v_mov_b32 v239, 0
  v_mov_b32 v240, 0
  v_mov_b32 v241, 0
  v_mov_b32 v242, 0
  v_mov_b32 v243, 0
  v_mov_b32 v244, 0
  v_mov_b32 v245, 0
  v_mov_b32 v246, 0
  v_mov_b32 v247, 0
  v_mov_b32 v248, 0
  v_mov_b32 v249, 0
  v_mov_b32 v250, 0
  v_mov_b32 v251, 0
  v_mov_b32 v252, 0
  v_mov_b32 v253, 0
  v_mov_b32 v254, 0
  v_mov_b32 v255, 0
  s_setprio 2
  s_mov_b32 s3, 0
  s_mov_b32 exec_lo, 0xffffffff
  s_mov_b32 exec_hi, 0
L_poll_qkv:
  buffer_load_dword v125, v124, s[52:55], s9 offen sc1
  s_add_u32 s3, s3, 1
  s_waitcnt vmcnt(0)
  v_cmp_ne_u32 vcc, s75, v125
  s_cmp_gt_u32 s3, 0x40000
  s_cbranch_vccz L_polld_qkv
  s_cbranch_scc1 L_polld_qkv
  s_sleep 2
  s_branch L_poll_qkv
L_polld_qkv:
  s_mov_b64 exec, -1
  buffer_load_dwordx4 v[4:7], v2, s[52:55], s12 offen offset:0 sc1
  buffer_load_dwordx4 v[76:79], v2, s[56:59], s71 offen sc1
  buffer_load_dwordx4 v[8:11], v2, s[52:55], s12 offen offset:1024 sc1
  s_mov_b64 exec, s[76:77]
  buffer_load_dwordx4 v[80:83], v3, s[56:59], s71 offen offset:1024 sc1
  buffer_load_dwordx4 v[84:87], v3, s[56:59], s71 offen offset:1536 sc1
  s_mov_b64 exec, -1
  s_add_u32 s71, s71, 0x800
  buffer_load_dwordx4 v[12:15], v2, s[52:55], s13 offen offset:0 sc1
  buffer_load_dwordx4 v[16:19], v2, s[52:55], s13 offen offset:1024 sc1
  buffer_load_dwordx4 v[20:23], v2, s[52:55], s14 offen offset:0 sc1
  buffer_load_dwordx4 v[24:27], v2, s[52:55], s14 offen offset:1024 sc1
  buffer_load_dwordx4 v[28:31], v2, s[52:55], s15 offen offset:0 sc1
  buffer_load_dwordx4 v[32:35], v2, s[52:55], s15 offen offset:1024 sc1
  buffer_load_dwordx4 v[88:91], v2, s[56:59], s71 offen sc1
  s_mov_b64 exec, s[76:77]
  buffer_load_dwordx4 v[92:95], v3, s[56:59], s71 offen offset:1024 sc1
  buffer_load_dwordx4 v[96:99], v3, s[56:59], s71 offen offset:1536 sc1
  s_mov_b64 exec, -1
  s_add_u32 s71, s71, 0x800
  buffer_load_dwordx4 v[100:103], v2, s[56:59], s71 offen sc1
  s_mov_b64 exec, s[76:77]
  buffer_load_dwordx4 v[104:107], v3, s[56:59], s71 offen offset:1024 sc1
  buffer_load_dwordx4 v[108:111], v3, s[56:59], s71 offen offset:1536 sc1
  s_mov_b64 exec, -1
  s_add_u32 s71, s71, 0x800
  s_barrier
  s_mov_b64 vcc, -1
  s_waitcnt vmcnt(15)
  v_mfma_f32_32x32x16_bf16 v[36:51], v[76:79], v[4:7], 0
  s_nop 11
  v_exp_f32 v36, v36
  v_exp_f32 v37, v37
  v_exp_f32 v38, v38
  v_exp_f32 v39, v39
  v_exp_f32 v40, v40
  v_exp_f32 v41, v41
  s_waitcnt vmcnt(6)
  s_branch L_at_entry
.p2align 6
L_at_loop:
  v_mfma_f32_32x32x16_bf16 v[240:255], v[116:119], v[68:71], v[240:255]
  v_exp_f32 v36, v36
  v_exp_f32 v37, v37
  v_exp_f32 v38, v38
  v_mfma_f32_32x32x16_bf16 v[240:255], v[120:123], v[72:75], v[240:255]
  v_exp_f32 v39, v39
  v_exp_f32 v40, v40
  v_exp_f32 v41, v41
L_at_entry:
  v_mfma_f32_32x32x16_bf16 v[52:67], v[76:79], v[8:11], 0
  v_exp_f32 v42, v42
  v_exp_f32 v43, v43
  v_exp_f32 v44, v44
  v_exp_f32 v45, v45
  buffer_load_dwordx4 v[112:115], v2, s[56:59], s71 offen sc1
  v_cvt_pk_bf16_f32 v68, v36, v37
  v_cvt_pk_bf16_f32 v69, v38, v39
  v_cvt_pk_bf16_f32 v70, v40, v41
  v_cvt_pk_bf16_f32 v71, v42, v43
  s_mov_b64 exec, s[76:77]
  buffer_load_dwordx4 v[116:119], v3, s[56:59], s71 offen offset:1024 sc1
  buffer_load_dwordx4 v[120:123], v3, s[56:59], s71 offen offset:1536 sc1
  s_mov_b64 exec, -1
  s_add_u32 s71, s71, 0x800
  v_exp_f32 v46, v46
  v_exp_f32 v47, v47
  v_exp_f32 v48, v48
  v_exp_f32 v49, v49
  v_exp_f32 v50, v50
  v_exp_f32 v51, v51
  v_cvt_pk_bf16_f32 v72, v44, v45
  v_cvt_pk_bf16_f32 v73, v46, v47
  v_cvt_pk_bf16_f32 v74, v48, v49
  v_cvt_pk_bf16_f32 v75, v50, v51
  v_mfma_f32_32x32x16_bf16 v[128:143], v[80:83], v[68:71], v[128:143]
  v_exp_f32 v52, v52
  v_exp_f32 v53, v53
  v_exp_f32 v54, v54
  v_mfma_f32_32x32x16_bf16 v[128:143], v[84:87], v[72:75], v[128:143]
  v_exp_f32 v55, v55
  v_exp_f32 v56, v56
  v_exp_f32 v57, v57
  v_mfma_f32_32x32x16_bf16 v[36:51], v[76:79], v[12:15], 0
  v_exp_f32 v58, v58
  v_exp_f32 v59, v59
  v_exp_f32 v60, v60
  v_exp_f32 v61, v61
  v_cvt_pk_bf16_f32 v68, v52, v53
  v_cvt_pk_bf16_f32 v69, v54, v55
  v_cvt_pk_bf16_f32 v70, v56, v57
  v_cvt_pk_bf16_f32 v71, v58, v59
  v_exp_f32 v62, v62
  v_exp_f32 v63, v63
  v_exp_f32 v64, v64
  v_exp_f32 v65, v65
  v_exp_f32 v66, v66
  v_exp_f32 v67, v67
  v_cvt_pk_bf16_f32 v72, v60, v61
  v_cvt_pk_bf16_f32 v73, v62, v63
  v_cvt_pk_bf16_f32 v74, v64, v65
  v_cvt_pk_bf16_f32 v75, v66, v67
  v_mfma_f32_32x32x16_bf16 v[144:159], v[80:83], v[68:71], v[144:159]
  v_exp_f32 v36, v36
  v_exp_f32 v37, v37
  v_exp_f32 v38, v38
  v_mfma_f32_32x32x16_bf16 v[144:159], v[84:87], v[72:75], v[144:159]
  v_exp_f32 v39, v39
  v_exp_f32 v40, v40
  v_exp_f32 v41, v41
  v_mfma_f32_32x32x16_bf16 v[52:67], v[76:79], v[16:19], 0
  v_exp_f32 v42, v42
  v_exp_f32 v43, v43
  v_exp_f32 v44, v44
  v_exp_f32 v45, v45
  v_cvt_pk_bf16_f32 v68, v36, v37
  v_cvt_pk_bf16_f32 v69, v38, v39
  v_cvt_pk_bf16_f32 v70, v40, v41
  v_cvt_pk_bf16_f32 v71, v42, v43
  v_exp_f32 v46, v46
  v_exp_f32 v47, v47
  v_exp_f32 v48, v48
  v_exp_f32 v49, v49
  v_exp_f32 v50, v50
  v_exp_f32 v51, v51
  v_cvt_pk_bf16_f32 v72, v44, v45
  v_cvt_pk_bf16_f32 v73, v46, v47
  v_cvt_pk_bf16_f32 v74, v48, v49
  v_cvt_pk_bf16_f32 v75, v50, v51
  v_mfma_f32_32x32x16_bf16 v[160:175], v[80:83], v[68:71], v[160:175]
  v_exp_f32 v52, v52
  v_exp_f32 v53, v53
  v_exp_f32 v54, v54
  v_mfma_f32_32x32x16_bf16 v[160:175], v[84:87], v[72:75], v[160:175]
  v_exp_f32 v55, v55
  v_exp_f32 v56, v56
  v_exp_f32 v57, v57
  v_mfma_f32_32x32x16_bf16 v[36:51], v[76:79], v[20:23], 0
  v_exp_f32 v58, v58
  v_exp_f32 v59, v59
  v_exp_f32 v60, v60
  v_exp_f32 v61, v61
  v_cvt_pk_bf16_f32 v68, v52, v53
  v_cvt_pk_bf16_f32 v69, v54, v55
  v_cvt_pk_bf16_f32 v70, v56, v57
  v_cvt_pk_bf16_f32 v71, v58, v59
  v_exp_f32 v62, v62
  v_exp_f32 v63, v63
  v_exp_f32 v64, v64
  v_exp_f32 v65, v65
  v_exp_f32 v66, v66
  v_exp_f32 v67, v67
  v_cvt_pk_bf16_f32 v72, v60, v61
  v_cvt_pk_bf16_f32 v73, v62, v63
  v_cvt_pk_bf16_f32 v74, v64, v65
  v_cvt_pk_bf16_f32 v75, v66, v67
  v_mfma_f32_32x32x16_bf16 v[176:191], v[80:83], v[68:71], v[176:191]
  v_exp_f32 v36, v36
  v_exp_f32 v37, v37
  v_exp_f32 v38, v38
  v_mfma_f32_32x32x16_bf16 v[176:191], v[84:87], v[72:75], v[176:191]
  v_exp_f32 v39, v39
  v_exp_f32 v40, v40
  v_exp_f32 v41, v41
  v_mfma_f32_32x32x16_bf16 v[52:67], v[76:79], v[24:27], 0
  v_exp_f32 v42, v42
  v_exp_f32 v43, v43
  v_exp_f32 v44, v44
  v_exp_f32 v45, v45
  v_cvt_pk_bf16_f32 v68, v36, v37
  v_cvt_pk_bf16_f32 v69, v38, v39
  v_cvt_pk_bf16_f32 v70, v40, v41
  v_cvt_pk_bf16_f32 v71, v42, v43
  v_exp_f32 v46, v46
  v_exp_f32 v47, v47
  v_exp_f32 v48, v48
  v_exp_f32 v49, v49
  v_exp_f32 v50, v50
  v_exp_f32 v51, v51
  v_cvt_pk_bf16_f32 v72, v44, v45
  v_cvt_pk_bf16_f32 v73, v46, v47
  v_cvt_pk_bf16_f32 v74, v48, v49
  v_cvt_pk_bf16_f32 v75, v50, v51
  v_mfma_f32_32x32x16_bf16 v[192:207], v[80:83], v[68:71], v[192:207]
  v_exp_f32 v52, v52
  v_exp_f32 v53, v53
  v_exp_f32 v54, v54
  v_mfma_f32_32x32x16_bf16 v[192:207], v[84:87], v[72:75], v[192:207]
  v_exp_f32 v55, v55
  v_exp_f32 v56, v56
  v_exp_f32 v57, v57
  v_mfma_f32_32x32x16_bf16 v[36:51], v[76:79], v[28:31], 0
  v_exp_f32 v58, v58
  v_exp_f32 v59, v59
  v_exp_f32 v60, v60
  v_exp_f32 v61, v61
  v_cvt_pk_bf16_f32 v68, v52, v53
  v_cvt_pk_bf16_f32 v69, v54, v55
  v_cvt_pk_bf16_f32 v70, v56, v57
  v_cvt_pk_bf16_f32 v71, v58, v59
  v_exp_f32 v62, v62
  v_exp_f32 v63, v63
  v_exp_f32 v64, v64
  v_exp_f32 v65, v65
  v_exp_f32 v66, v66
  v_exp_f32 v67, v67
  v_cvt_pk_bf16_f32 v72, v60, v61
  v_cvt_pk_bf16_f32 v73, v62, v63
  v_cvt_pk_bf16_f32 v74, v64, v65
  v_cvt_pk_bf16_f32 v75, v66, v67
  v_mfma_f32_32x32x16_bf16 v[208:223], v[80:83], v[68:71], v[208:223]
  v_exp_f32 v36, v36
  v_exp_f32 v37, v37
  v_exp_f32 v38, v38
  v_mfma_f32_32x32x16_bf16 v[208:223], v[84:87], v[72:75], v[208:223]
  v_exp_f32 v39, v39
  v_exp_f32 v40, v40
  v_exp_f32 v41, v41
  v_mfma_f32_32x32x16_bf16 v[52:67], v[76:79], v[32:35], 0
  v_exp_f32 v42, v42
  v_exp_f32 v43, v43
  v_exp_f32 v44, v44
  v_exp_f32 v45, v45
  v_cvt_pk_bf16_f32 v68, v36, v37
  v_cvt_pk_bf16_f32 v69, v38, v39
  v_cvt_pk_bf16_f32 v70, v40, v41
  v_cvt_pk_bf16_f32 v71, v42, v43
  v_exp_f32 v46, v46
  v_exp_f32 v47, v47
  v_exp_f32 v48, v48
  v_exp_f32 v49, v49
  v_exp_f32 v50, v50
  v_exp_f32 v51, v51
  v_cvt_pk_bf16_f32 v72, v44, v45
  v_cvt_pk_bf16_f32 v73, v46, v47
  v_cvt_pk_bf16_f32 v74, v48, v49
  v_cvt_pk_bf16_f32 v75, v50, v51
  v_mfma_f32_32x32x16_bf16 v[224:239], v[80:83], v[68:71], v[224:239]
  v_exp_f32 v52, v52
  v_exp_f32 v53, v53
  v_exp_f32 v54, v54
  v_mfma_f32_32x32x16_bf16 v[224:239], v[84:87], v[72:75], v[224:239]
  v_exp_f32 v55, v55
  v_exp_f32 v56, v56
  v_exp_f32 v57, v57
  s_waitcnt vmcnt(6)
  v_mfma_f32_32x32x16_bf16 v[36:51], v[88:91], v[4:7], 0
  v_exp_f32 v58, v58
  v_exp_f32 v59, v59
  v_exp_f32 v60, v60
  v_exp_f32 v61, v61
  v_cvt_pk_bf16_f32 v68, v52, v53
  v_cvt_pk_bf16_f32 v69, v54, v55
  v_cvt_pk_bf16_f32 v70, v56, v57
  v_cvt_pk_bf16_f32 v71, v58, v59
  v_exp_f32 v62, v62
  v_exp_f32 v63, v63
  v_exp_f32 v64, v64
  v_exp_f32 v65, v65
  v_exp_f32 v66, v66
  v_exp_f32 v67, v67
  v_cvt_pk_bf16_f32 v72, v60, v61
  v_cvt_pk_bf16_f32 v73, v62, v63
  v_cvt_pk_bf16_f32 v74, v64, v65
  v_cvt_pk_bf16_f32 v75, v66, v67
  v_mfma_f32_32x32x16_bf16 v[240:255], v[80:83], v[68:71], v[240:255]
  v_exp_f32 v36, v36
  v_exp_f32 v37, v37
  v_exp_f32 v38, v38
  v_mfma_f32_32x32x16_bf16 v[240:255], v[84:87], v[72:75], v[240:255]
  v_exp_f32 v39, v39
  v_exp_f32 v40, v40
  v_exp_f32 v41, v41
  v_mfma_f32_32x32x16_bf16 v[52:67], v[88:91], v[8:11], 0
  v_exp_f32 v42, v42
  v_exp_f32 v43, v43
  v_exp_f32 v44, v44
  v_exp_f32 v45, v45
  v_cvt_pk_bf16_f32 v68, v36, v37
  v_cvt_pk_bf16_f32 v69, v38, v39
  v_cvt_pk_bf16_f32 v70, v40, v41
  v_cvt_pk_bf16_f32 v71, v42, v43
  s_cbranch_vccz L_kvs_8
  buffer_load_dwordx4 v[76:79], v2, s[56:59], s71 offen sc1
  s_mov_b64 exec, s[76:77]
  buffer_load_dwordx4 v[80:83], v3, s[56:59], s71 offen offset:1024 sc1
  buffer_load_dwordx4 v[84:87], v3, s[56:59], s71 offen offset:1536 sc1
  s_mov_b64 exec, -1
  s_add_u32 s71, s71, 0x800
L_kvr_8:
  v_exp_f32 v46, v46
  v_exp_f32 v47, v47
  v_exp_f32 v48, v48
  v_exp_f32 v49, v49
  v_exp_f32 v50, v50
  v_exp_f32 v51, v51
  v_cvt_pk_bf16_f32 v72, v44, v45
  v_cvt_pk_bf16_f32 v73, v46, v47
  v_cvt_pk_bf16_f32 v74, v48, v49
  v_cvt_pk_bf16_f32 v75, v50, v51
  v_mfma_f32_32x32x16_bf16 v[128:143], v[92:95], v[68:71], v[128:143]
  v_exp_f32 v52, v52
  v_exp_f32 v53, v53
  v_exp_f32 v54, v54
  v_mfma_f32_32x32x16_bf16 v[128:143], v[96:99], v[72:75], v[128:143]
  v_exp_f32 v55, v55
  v_exp_f32 v56, v56
  v_exp_f32 v57, v57
  v_mfma_f32_32x32x16_bf16 v[36:51], v[88:91], v[12:15], 0
  v_exp_f32 v58, v58
  v_exp_f32 v59, v59
  v_exp_f32 v60, v60
  v_exp_f32 v61, v61
  v_cvt_pk_bf16_f32 v68, v52, v53
  v_cvt_pk_bf16_f32 v69, v54, v55
  v_cvt_pk_bf16_f32 v70, v56, v57
  v_cvt_pk_bf16_f32 v71, v58, v59
  v_exp_f32 v62, v62
  v_exp_f32 v63, v63
  v_exp_f32 v64, v64
  v_exp_f32 v65, v65
  v_exp_f32 v66, v66
  v_exp_f32 v67, v67
  v_cvt_pk_bf16_f32 v72, v60, v61
  v_cvt_pk_bf16_f32 v73, v62, v63
  v_cvt_pk_bf16_f32 v74, v64, v65
  v_cvt_pk_bf16_f32 v75, v66, v67
  v_mfma_f32_32x32x16_bf16 v[144:159], v[92:95], v[68:71], v[144:159]
  v_exp_f32 v36, v36
  v_exp_f32 v37, v37
  v_exp_f32 v38, v38
  v_mfma_f32_32x32x16_bf16 v[144:159], v[96:99], v[72:75], v[144:159]
  v_exp_f32 v39, v39
  v_exp_f32 v40, v40
  v_exp_f32 v41, v41
  v_mfma_f32_32x32x16_bf16 v[52:67], v[88:91], v[16:19], 0
  v_exp_f32 v42, v42
  v_exp_f32 v43, v43
  v_exp_f32 v44, v44
  v_exp_f32 v45, v45
  v_cvt_pk_bf16_f32 v68, v36, v37
  v_cvt_pk_bf16_f32 v69, v38, v39
  v_cvt_pk_bf16_f32 v70, v40, v41
  v_cvt_pk_bf16_f32 v71, v42, v43
  v_exp_f32 v46, v46
  v_exp_f32 v47, v47
  v_exp_f32 v48, v48
  v_exp_f32 v49, v49
  v_exp_f32 v50, v50
  v_exp_f32 v51, v51
  v_cvt_pk_bf16_f32 v72, v44, v45
  v_cvt_pk_bf16_f32 v73, v46, v47
  v_cvt_pk_bf16_f32 v74, v48, v49
  v_cvt_pk_bf16_f32 v75, v50, v51
  v_mfma_f32_32x32x16_bf16 v[160:175], v[92:95], v[68:71], v[160:175]
  v_exp_f32 v52, v52
  v_exp_f32 v53, v53
  v_exp_f32 v54, v54
  v_mfma_f32_32x32x16_bf16 v[160:175], v[96:99], v[72:75], v[160:175]
  v_exp_f32 v55, v55
  v_exp_f32 v56, v56
  v_exp_f32 v57, v57
  v_mfma_f32_32x32x16_bf16 v[36:51], v[88:91], v[20:23], 0
  v_exp_f32 v58, v58
  v_exp_f32 v59, v59
  v_exp_f32 v60, v60
  v_exp_f32 v61, v61
  v_cvt_pk_bf16_f32 v68, v52, v53
  v_cvt_pk_bf16_f32 v69, v54, v55
  v_cvt_pk_bf16_f32 v70, v56, v57
  v_cvt_pk_bf16_f32 v71, v58, v59
  v_exp_f32 v62, v62
  v_exp_f32 v63, v63
  v_exp_f32 v64, v64
  v_exp_f32 v65, v65
  v_exp_f32 v66, v66
  v_exp_f32 v67, v67
  v_cvt_pk_bf16_f32 v72, v60, v61
  v_cvt_pk_bf16_f32 v73, v62, v63
  v_cvt_pk_bf16_f32 v74, v64, v65
  v_cvt_pk_bf16_f32 v75, v66, v67
  v_mfma_f32_32x32x16_bf16 v[176:191], v[92:95], v[68:71], v[176:191]
  v_exp_f32 v36, v36
  v_exp_f32 v37, v37
  v_exp_f32 v38, v38
  v_mfma_f32_32x32x16_bf16 v[176:191], v[96:99], v[72:75], v[176:191]
  v_exp_f32 v39, v39
  v_exp_f32 v40, v40
  v_exp_f32 v41, v41
  v_mfma_f32_32x32x16_bf16 v[52:67], v[88:91], v[24:27], 0
  v_exp_f32 v42, v42
  v_exp_f32 v43, v43
  v_exp_f32 v44, v44
  v_exp_f32 v45, v45
  v_cvt_pk_bf16_f32 v68, v36, v37
  v_cvt_pk_bf16_f32 v69, v38, v39
  v_cvt_pk_bf16_f32 v70, v40, v41
  v_cvt_pk_bf16_f32 v71, v42, v43
  v_exp_f32 v46, v46
  v_exp_f32 v47, v47
  v_exp_f32 v48, v48
  v_exp_f32 v49, v49
  v_exp_f32 v50, v50
  v_exp_f32 v51, v51
  v_cvt_pk_bf16_f32 v72, v44, v45
  v_cvt_pk_bf16_f32 v73, v46, v47
  v_cvt_pk_bf16_f32 v74, v48, v49
  v_cvt_pk_bf16_f32 v75, v50, v51
  v_mfma_f32_32x32x16_bf16 v[192:207], v[92:95], v[68:71], v[192:207]
  v_exp_f32 v52, v52
  v_exp_f32 v53, v53
  v_exp_f32 v54, v54
  v_mfma_f32_32x32x16_bf16 v[192:207], v[96:99], v[72:75], v[192:207]
  v_exp_f32 v55, v55
  v_exp_f32 v56, v56
  v_exp_f32 v57, v57
  v_mfma_f32_32x32x16_bf16 v[36:51], v[88:91], v[28:31], 0
  v_exp_f32 v58, v58
  v_exp_f32 v59, v59
  v_exp_f32 v60, v60
  v_exp_f32 v61, v61
  v_cvt_pk_bf16_f32 v68, v52, v53
  v_cvt_pk_bf16_f32 v69, v54, v55
  v_cvt_pk_bf16_f32 v70, v56, v57
  v_cvt_pk_bf16_f32 v71, v58, v59
  v_exp_f32 v62, v62
  v_exp_f32 v63, v63
  v_exp_f32 v64, v64
  v_exp_f32 v65, v65
  v_exp_f32 v66, v66
  v_exp_f32 v67, v67
  v_cvt_pk_bf16_f32 v72, v60, v61
  v_cvt_pk_bf16_f32 v73, v62, v63
  v_cvt_pk_bf16_f32 v74, v64, v65
  v_cvt_pk_bf16_f32 v75, v66, v67
  v_mfma_f32_32x32x16_bf16 v[208:223], v[92:95], v[68:71], v[208:223]
  v_exp_f32 v36, v36
  v_exp_f32 v37, v37
  v_exp_f32 v38, v38
  v_mfma_f32_32x32x16_bf16 v[208:223], v[96:99], v[72:75], v[208:223]
  v_exp_f32 v39, v39
  v_exp_f32 v40, v40
  v_exp_f32 v41, v41
  v_mfma_f32_32x32x16_bf16 v[52:67], v[88:91], v[32:35], 0
  v_exp_f32 v42, v42
  v_exp_f32 v43, v43
  v_exp_f32 v44, v44
  v_exp_f32 v45, v45
  v_cvt_pk_bf16_f32 v68, v36, v37
  v_cvt_pk_bf16_f32 v69, v38, v39
  v_cvt_pk_bf16_f32 v70, v40, v41
  v_cvt_pk_bf16_f32 v71, v42, v43
  v_exp_f32 v46, v46
  v_exp_f32 v47, v47
  v_exp_f32 v48, v48
  v_exp_f32 v49, v49
  v_exp_f32 v50, v50
  v_exp_f32 v51, v51
  v_cvt_pk_bf16_f32 v72, v44, v45
  v_cvt_pk_bf16_f32 v73, v46, v47
  v_cvt_pk_bf16_f32 v74, v48, v49
  v_cvt_pk_bf16_f32 v75, v50, v51
  v_mfma_f32_32x32x16_bf16 v[224:239], v[92:95], v[68:71], v[224:239]
  v_exp_f32 v52, v52
  v_exp_f32 v53, v53
  v_exp_f32 v54, v54
  v_mfma_f32_32x32x16_bf16 v[224:239], v[96:99], v[72:75], v[224:239]
  v_exp_f32 v55, v55
  v_exp_f32 v56, v56
  v_exp_f32 v57, v57
  s_waitcnt vmcnt(6)
  v_mfma_f32_32x32x16_bf16 v[36:51], v[100:103], v[4:7], 0
  v_exp_f32 v58, v58
  v_exp_f32 v59, v59
  v_exp_f32 v60, v60
  v_exp_f32 v61, v61
  v_cvt_pk_bf16_f32 v68, v52, v53
  v_cvt_pk_bf16_f32 v69, v54, v55
  v_cvt_pk_bf16_f32 v70, v56, v57
  v_cvt_pk_bf16_f32 v71, v58, v59
  v_exp_f32 v62, v62
  v_exp_f32 v63, v63
  v_exp_f32 v64, v64
  v_exp_f32 v65, v65
  v_exp_f32 v66, v66
  v_exp_f32 v67, v67
  v_cvt_pk_bf16_f32 v72, v60, v61
  v_cvt_pk_bf16_f32 v73, v62, v63
  v_cvt_pk_bf16_f32 v74, v64, v65
  v_cvt_pk_bf16_f32 v75, v66, v67
  v_mfma_f32_32x32x16_bf16 v[240:255], v[92:95], v[68:71], v[240:255]
  v_exp_f32 v36, v36
  v_exp_f32 v37, v37
  v_exp_f32 v38, v38
  v_mfma_f32_32x32x16_bf16 v[240:255], v[96:99], v[72:75], v[240:255]
  v_exp_f32 v39, v39
  v_exp_f32 v40, v40
  v_exp_f32 v41, v41
  v_mfma_f32_32x32x16_bf16 v[52:67], v[100:103], v[8:11], 0
  v_exp_f32 v42, v42
  v_exp_f32 v43, v43
  v_exp_f32 v44, v44
  v_exp_f32 v45, v45
  v_cvt_pk_bf16_f32 v68, v36, v37
  v_cvt_pk_bf16_f32 v69, v38, v39
  v_cvt_pk_bf16_f32 v70, v40, v41
  v_cvt_pk_bf16_f32 v71, v42, v43
  s_cbranch_vccz L_kvs_16
  buffer_load_dwordx4 v[88:91], v2, s[56:59], s71 offen sc1
  s_mov_b64 exec, s[76:77]
  buffer_load_dwordx4 v[92:95], v3, s[56:59], s71 offen offset:1024 sc1
  buffer_load_dwordx4 v[96:99], v3, s[56:59], s71 offen offset:1536 sc1
  s_mov_b64 exec, -1
  s_add_u32 s71, s71, 0x800
L_kvr_16:
  v_exp_f32 v46, v46
  v_exp_f32 v47, v47
  v_exp_f32 v48, v48
  v_exp_f32 v49, v49
  v_exp_f32 v50, v50
  v_exp_f32 v51, v51
  v_cvt_pk_bf16_f32 v72, v44, v45
  v_cvt_pk_bf16_f32 v73, v46, v47
  v_cvt_pk_bf16_f32 v74, v48, v49
  v_cvt_pk_bf16_f32 v75, v50, v51
  v_mfma_f32_32x32x16_bf16 v[128:143], v[104:107], v[68:71], v[128:143]
  v_exp_f32 v52, v52
  v_exp_f32 v53, v53
  v_exp_f32 v54, v54
  v_mfma_f32_32x32x16_bf16 v[128:143], v[108:111], v[72:75], v[128:143]
  v_exp_f32 v55, v55
  v_exp_f32 v56, v56
  v_exp_f32 v57, v57
  v_mfma_f32_32x32x16_bf16 v[36:51], v[100:103], v[12:15], 0
  v_exp_f32 v58, v58
  v_exp_f32 v59, v59
  v_exp_f32 v60, v60
  v_exp_f32 v61, v61
  v_cvt_pk_bf16_f32 v68, v52, v53
  v_cvt_pk_bf16_f32 v69, v54, v55
  v_cvt_pk_bf16_f32 v70, v56, v57
  v_cvt_pk_bf16_f32 v71, v58, v59
  v_exp_f32 v62, v62
  v_exp_f32 v63, v63
  v_exp_f32 v64, v64
  v_exp_f32 v65, v65
  v_exp_f32 v66, v66
  v_exp_f32 v67, v67
  v_cvt_pk_bf16_f32 v72, v60, v61
  v_cvt_pk_bf16_f32 v73, v62, v63
  v_cvt_pk_bf16_f32 v74, v64, v65
  v_cvt_pk_bf16_f32 v75, v66, v67
  v_mfma_f32_32x32x16_bf16 v[144:159], v[104:107], v[68:71], v[144:159]
  v_exp_f32 v36, v36
  v_exp_f32 v37, v37
  v_exp_f32 v38, v38
  v_mfma_f32_32x32x16_bf16 v[144:159], v[108:111], v[72:75], v[144:159]
  v_exp_f32 v39, v39
  v_exp_f32 v40, v40
  v_exp_f32 v41, v41
  v_mfma_f32_32x32x16_bf16 v[52:67], v[100:103], v[16:19], 0
  v_exp_f32 v42, v42
  v_exp_f32 v43, v43
  v_exp_f32 v44, v44
  v_exp_f32 v45, v45
  v_cvt_pk_bf16_f32 v68, v36, v37
  v_cvt_pk_bf16_f32 v69, v38, v39
  v_cvt_pk_bf16_f32 v70, v40, v41
  v_cvt_pk_bf16_f32 v71, v42, v43
  v_exp_f32 v46, v46
  v_exp_f32 v47, v47
  v_exp_f32 v48, v48
  v_exp_f32 v49, v49
  v_exp_f32 v50, v50
  v_exp_f32 v51, v51
  v_cvt_pk_bf16_f32 v72, v44, v45
  v_cvt_pk_bf16_f32 v73, v46, v47
  v_cvt_pk_bf16_f32 v74, v48, v49
  v_cvt_pk_bf16_f32 v75, v50, v51
  v_mfma_f32_32x32x16_bf16 v[160:175], v[104:107], v[68:71], v[160:175]
  v_exp_f32 v52, v52
  v_exp_f32 v53, v53
  v_exp_f32 v54, v54
  v_mfma_f32_32x32x16_bf16 v[160:175], v[108:111], v[72:75], v[160:175]
  v_exp_f32 v55, v55
  v_exp_f32 v56, v56
  v_exp_f32 v57, v57
  v_mfma_f32_32x32x16_bf16 v[36:51], v[100:103], v[20:23], 0
  v_exp_f32 v58, v58
  v_exp_f32 v59, v59
  v_exp_f32 v60, v60
  v_exp_f32 v61, v61
  v_cvt_pk_bf16_f32 v68, v52, v53
  v_cvt_pk_bf16_f32 v69, v54, v55
  v_cvt_pk_bf16_f32 v70, v56, v57
  v_cvt_pk_bf16_f32 v71, v58, v59
  v_exp_f32 v62, v62
  v_exp_f32 v63, v63
  v_exp_f32 v64, v64
  v_exp_f32 v65, v65
  v_exp_f32 v66, v66
  v_exp_f32 v67, v67
  v_cvt_pk_bf16_f32 v72, v60, v61
  v_cvt_pk_bf16_f32 v73, v62, v63
  v_cvt_pk_bf16_f32 v74, v64, v65
  v_cvt_pk_bf16_f32 v75, v66, v67
  v_mfma_f32_32x32x16_bf16 v[176:191], v[104:107], v[68:71], v[176:191]
  v_exp_f32 v36, v36
  v_exp_f32 v37, v37
  v_exp_f32 v38, v38
  v_mfma_f32_32x32x16_bf16 v[176:191], v[108:111], v[72:75], v[176:191]
  v_exp_f32 v39, v39
  v_exp_f32 v40, v40
  v_exp_f32 v41, v41
  v_mfma_f32_32x32x16_bf16 v[52:67], v[100:103], v[24:27], 0
  v_exp_f32 v42, v42
  v_exp_f32 v43, v43
  v_exp_f32 v44, v44
  v_exp_f32 v45, v45
  v_cvt_pk_bf16_f32 v68, v36, v37
  v_cvt_pk_bf16_f32 v69, v38, v39
  v_cvt_pk_bf16_f32 v70, v40, v41
  v_cvt_pk_bf16_f32 v71, v42, v43
  v_exp_f32 v46, v46
  v_exp_f32 v47, v47
  v_exp_f32 v48, v48
  v_exp_f32 v49, v49
  v_exp_f32 v50, v50
  v_exp_f32 v51, v51
  v_cvt_pk_bf16_f32 v72, v44, v45
  v_cvt_pk_bf16_f32 v73, v46, v47
  v_cvt_pk_bf16_f32 v74, v48, v49
  v_cvt_pk_bf16_f32 v75, v50, v51
  v_mfma_f32_32x32x16_bf16 v[192:207], v[104:107], v[68:71], v[192:207]
  v_exp_f32 v52, v52
  v_exp_f32 v53, v53
  v_exp_f32 v54, v54
  v_mfma_f32_32x32x16_bf16 v[192:207], v[108:111], v[72:75], v[192:207]
  v_exp_f32 v55, v55
  v_exp_f32 v56, v56
  v_exp_f32 v57, v57
  v_mfma_f32_32x32x16_bf16 v[36:51], v[100:103], v[28:31], 0
  v_exp_f32 v58, v58
  v_exp_f32 v59, v59
  v_exp_f32 v60, v60
  v_exp_f32 v61, v61
  v_cvt_pk_bf16_f32 v68, v52, v53
  v_cvt_pk_bf16_f32 v69, v54, v55
  v_cvt_pk_bf16_f32 v70, v56, v57
  v_cvt_pk_bf16_f32 v71, v58, v59
  v_exp_f32 v62, v62
  v_exp_f32 v63, v63
  v_exp_f32 v64, v64
  v_exp_f32 v65, v65
  v_exp_f32 v66, v66
  v_exp_f32 v67, v67
  v_cvt_pk_bf16_f32 v72, v60, v61
  v_cvt_pk_bf16_f32 v73, v62, v63
  v_cvt_pk_bf16_f32 v74, v64, v65
  v_cvt_pk_bf16_f32 v75, v66, v67
  v_mfma_f32_32x32x16_bf16 v[208:223], v[104:107], v[68:71], v[208:223]
  v_exp_f32 v36, v36
  v_exp_f32 v37, v37
  v_exp_f32 v38, v38
  v_mfma_f32_32x32x16_bf16 v[208:223], v[108:111], v[72:75], v[208:223]
  v_exp_f32 v39, v39
  v_exp_f32 v40, v40
  v_exp_f32 v41, v41
  v_mfma_f32_32x32x16_bf16 v[52:67], v[100:103], v[32:35], 0
  v_exp_f32 v42, v42
  v_exp_f32 v43, v43
  v_exp_f32 v44, v44
  v_exp_f32 v45, v45
  v_cvt_pk_bf16_f32 v68, v36, v37
  v_cvt_pk_bf16_f32 v69, v38, v39
  v_cvt_pk_bf16_f32 v70, v40, v41
  v_cvt_pk_bf16_f32 v71, v42, v43
  v_exp_f32 v46, v46
  v_exp_f32 v47, v47
  v_exp_f32 v48, v48
  v_exp_f32 v49, v49
  v_exp_f32 v50, v50
  v_exp_f32 v51, v51
  v_cvt_pk_bf16_f32 v72, v44, v45
  v_cvt_pk_bf16_f32 v73, v46, v47
  v_cvt_pk_bf16_f32 v74, v48, v49
  v_cvt_pk_bf16_f32 v75, v50, v51
  v_mfma_f32_32x32x16_bf16 v[224:239], v[104:107], v[68:71], v[224:239]
  v_exp_f32 v52, v52
  v_exp_f32 v53, v53
  v_exp_f32 v54, v54
  v_mfma_f32_32x32x16_bf16 v[224:239], v[108:111], v[72:75], v[224:239]
  v_exp_f32 v55, v55
  v_exp_f32 v56, v56
  v_exp_f32 v57, v57
  s_waitcnt vmcnt(6)
  v_mfma_f32_32x32x16_bf16 v[36:51], v[112:115], v[4:7], 0
  v_exp_f32 v58, v58
  v_exp_f32 v59, v59
  v_exp_f32 v60, v60
  v_exp_f32 v61, v61
  v_cvt_pk_bf16_f32 v68, v52, v53
  v_cvt_pk_bf16_f32 v69, v54, v55
  v_cvt_pk_bf16_f32 v70, v56, v57
  v_cvt_pk_bf16_f32 v71, v58, v59
  v_exp_f32 v62, v62
  v_exp_f32 v63, v63
  v_exp_f32 v64, v64
  v_exp_f32 v65, v65
  v_exp_f32 v66, v66
  v_exp_f32 v67, v67
  v_cvt_pk_bf16_f32 v72, v60, v61
  v_cvt_pk_bf16_f32 v73, v62, v63
  v_cvt_pk_bf16_f32 v74, v64, v65
  v_cvt_pk_bf16_f32 v75, v66, v67
  v_mfma_f32_32x32x16_bf16 v[240:255], v[104:107], v[68:71], v[240:255]
  v_exp_f32 v36, v36
  v_exp_f32 v37, v37
  v_exp_f32 v38, v38
  v_mfma_f32_32x32x16_bf16 v[240:255], v[108:111], v[72:75], v[240:255]
  v_exp_f32 v39, v39
  v_exp_f32 v40, v40
  v_exp_f32 v41, v41
  v_mfma_f32_32x32x16_bf16 v[52:67], v[112:115], v[8:11], 0
  v_exp_f32 v42, v42
  v_exp_f32 v43, v43
  v_exp_f32 v44, v44
  v_exp_f32 v45, v45
  v_cvt_pk_bf16_f32 v68, v36, v37
  v_cvt_pk_bf16_f32 v69, v38, v39
  v_cvt_pk_bf16_f32 v70, v40, v41
  v_cvt_pk_bf16_f32 v71, v42, v43
  s_cbranch_vccz L_at_last
  buffer_load_dwordx4 v[100:103], v2, s[56:59], s71 offen sc1
  s_mov_b64 exec, s[76:77]
  buffer_load_dwordx4 v[104:107], v3, s[56:59], s71 offen offset:1024 sc1
  buffer_load_dwordx4 v[108:111], v3, s[56:59], s71 offen offset:1536 sc1
  s_mov_b64 exec, -1
  s_add_u32 s71, s71, 0x800
  v_exp_f32 v46, v46
  v_exp_f32 v47, v47
  v_exp_f32 v48, v48
  v_exp_f32 v49, v49
  v_exp_f32 v50, v50
  v_exp_f32 v51, v51
  v_cvt_pk_bf16_f32 v72, v44, v45
  v_cvt_pk_bf16_f32 v73, v46, v47
  v_cvt_pk_bf16_f32 v74, v48, v49
  v_cvt_pk_bf16_f32 v75, v50, v51
  v_mfma_f32_32x32x16_bf16 v[128:143], v[116:119], v[68:71], v[128:143]
  v_exp_f32 v52, v52
  v_exp_f32 v53, v53
  v_exp_f32 v54, v54
  v_mfma_f32_32x32x16_bf16 v[128:143], v[120:123], v[72:75], v[128:143]
  v_exp_f32 v55, v55
  v_exp_f32 v56, v56
  v_exp_f32 v57, v57
  v_mfma_f32_32x32x16_bf16 v[36:51], v[112:115], v[12:15], 0
  v_exp_f32 v58, v58
  v_exp_f32 v59, v59
  v_exp_f32 v60, v60
  v_exp_f32 v61, v61
  v_cvt_pk_bf16_f32 v68, v52, v53
  v_cvt_pk_bf16_f32 v69, v54, v55
  v_cvt_pk_bf16_f32 v70, v56, v57
  v_cvt_pk_bf16_f32 v71, v58, v59
  v_exp_f32 v62, v62
  v_exp_f32 v63, v63
  v_exp_f32 v64, v64
  v_exp_f32 v65, v65
  v_exp_f32 v66, v66
  v_exp_f32 v67, v67
  v_cvt_pk_bf16_f32 v72, v60, v61
  v_cvt_pk_bf16_f32 v73, v62, v63
  v_cvt_pk_bf16_f32 v74, v64, v65
  v_cvt_pk_bf16_f32 v75, v66, v67
  v_mfma_f32_32x32x16_bf16 v[144:159], v[116:119], v[68:71], v[144:159]
  v_exp_f32 v36, v36
  v_exp_f32 v37, v37
  v_exp_f32 v38, v38
  v_mfma_f32_32x32x16_bf16 v[144:159], v[120:123], v[72:75], v[144:159]
  v_exp_f32 v39, v39
  v_exp_f32 v40, v40
  v_exp_f32 v41, v41
  v_mfma_f32_32x32x16_bf16 v[52:67], v[112:115], v[16:19], 0
  v_exp_f32 v42, v42
  v_exp_f32 v43, v43
  v_exp_f32 v44, v44
  v_exp_f32 v45, v45
  v_cvt_pk_bf16_f32 v68, v36, v37
  v_cvt_pk_bf16_f32 v69, v38, v39
  v_cvt_pk_bf16_f32 v70, v40, v41
  v_cvt_pk_bf16_f32 v71, v42, v43
  v_exp_f32 v46, v46
  v_exp_f32 v47, v47
  v_exp_f32 v48, v48
  v_exp_f32 v49, v49
  v_exp_f32 v50, v50
  v_exp_f32 v51, v51
  v_cvt_pk_bf16_f32 v72, v44, v45
  v_cvt_pk_bf16_f32 v73, v46, v47
  v_cvt_pk_bf16_f32 v74, v48, v49
  v_cvt_pk_bf16_f32 v75, v50, v51
  v_mfma_f32_32x32x16_bf16 v[160:175], v[116:119], v[68:71], v[160:175]
  v_exp_f32 v52, v52
  v_exp_f32 v53, v53
  v_exp_f32 v54, v54
  v_mfma_f32_32x32x16_bf16 v[160:175], v[120:123], v[72:75], v[160:175]
  v_exp_f32 v55, v55
  v_exp_f32 v56, v56
  v_exp_f32 v57, v57
  v_mfma_f32_32x32x16_bf16 v[36:51], v[112:115], v[20:23], 0
  v_exp_f32 v58, v58
  v_exp_f32 v59, v59
  v_exp_f32 v60, v60
  v_exp_f32 v61, v61
  v_cvt_pk_bf16_f32 v68, v52, v53
  v_cvt_pk_bf16_f32 v69, v54, v55
  v_cvt_pk_bf16_f32 v70, v56, v57
  v_cvt_pk_bf16_f32 v71, v58, v59
  v_exp_f32 v62, v62
  v_exp_f32 v63, v63
  v_exp_f32 v64, v64
  v_exp_f32 v65, v65
  v_exp_f32 v66, v66
  v_exp_f32 v67, v67
  v_cvt_pk_bf16_f32 v72, v60, v61
  v_cvt_pk_bf16_f32 v73, v62, v63
  v_cvt_pk_bf16_f32 v74, v64, v65
  v_cvt_pk_bf16_f32 v75, v66, v67
  v_mfma_f32_32x32x16_bf16 v[176:191], v[116:119], v[68:71], v[176:191]
  v_exp_f32 v36, v36
  v_exp_f32 v37, v37
  v_exp_f32 v38, v38
  v_mfma_f32_32x32x16_bf16 v[176:191], v[120:123], v[72:75], v[176:191]
  v_exp_f32 v39, v39
  v_exp_f32 v40, v40
  v_exp_f32 v41, v41
  v_mfma_f32_32x32x16_bf16 v[52:67], v[112:115], v[24:27], 0
  v_exp_f32 v42, v42
  v_exp_f32 v43, v43
  v_exp_f32 v44, v44
  v_exp_f32 v45, v45
  v_cvt_pk_bf16_f32 v68, v36, v37
  v_cvt_pk_bf16_f32 v69, v38, v39
  v_cvt_pk_bf16_f32 v70, v40, v41
  v_cvt_pk_bf16_f32 v71, v42, v43
  v_exp_f32 v46, v46
  v_exp_f32 v47, v47
  v_exp_f32 v48, v48
  v_exp_f32 v49, v49
  v_exp_f32 v50, v50
  v_exp_f32 v51, v51
  v_cvt_pk_bf16_f32 v72, v44, v45
  v_cvt_pk_bf16_f32 v73, v46, v47
  v_cvt_pk_bf16_f32 v74, v48, v49
  v_cvt_pk_bf16_f32 v75, v50, v51
  v_mfma_f32_32x32x16_bf16 v[192:207], v[116:119], v[68:71], v[192:207]
  v_exp_f32 v52, v52
  v_exp_f32 v53, v53
  v_exp_f32 v54, v54
  v_mfma_f32_32x32x16_bf16 v[192:207], v[120:123], v[72:75], v[192:207]
  v_exp_f32 v55, v55
  v_exp_f32 v56, v56
  v_exp_f32 v57, v57
  v_mfma_f32_32x32x16_bf16 v[36:51], v[112:115], v[28:31], 0
  v_exp_f32 v58, v58
  v_exp_f32 v59, v59
  v_exp_f32 v60, v60
  v_exp_f32 v61, v61
  v_cvt_pk_bf16_f32 v68, v52, v53
  v_cvt_pk_bf16_f32 v69, v54, v55
  v_cvt_pk_bf16_f32 v70, v56, v57
  v_cvt_pk_bf16_f32 v71, v58, v59
  v_exp_f32 v62, v62
  v_exp_f32 v63, v63
  v_exp_f32 v64, v64
  v_exp_f32 v65, v65
  v_exp_f32 v66, v66
  v_exp_f32 v67, v67
  v_cvt_pk_bf16_f32 v72, v60, v61
  v_cvt_pk_bf16_f32 v73, v62, v63
  v_cvt_pk_bf16_f32 v74, v64, v65
  v_cvt_pk_bf16_f32 v75, v66, v67
  v_mfma_f32_32x32x16_bf16 v[208:223], v[116:119], v[68:71], v[208:223]
  v_exp_f32 v36, v36
  v_exp_f32 v37, v37
  v_exp_f32 v38, v38
  v_mfma_f32_32x32x16_bf16 v[208:223], v[120:123], v[72:75], v[208:223]
  v_exp_f32 v39, v39
  v_exp_f32 v40, v40
  v_exp_f32 v41, v41
  v_mfma_f32_32x32x16_bf16 v[52:67], v[112:115], v[32:35], 0
  v_exp_f32 v42, v42
  v_exp_f32 v43, v43
  v_exp_f32 v44, v44
  v_exp_f32 v45, v45
  v_cvt_pk_bf16_f32 v68, v36, v37
  v_cvt_pk_bf16_f32 v69, v38, v39
  v_cvt_pk_bf16_f32 v70, v40, v41
  v_cvt_pk_bf16_f32 v71, v42, v43
  v_exp_f32 v46, v46
  v_exp_f32 v47, v47
  v_exp_f32 v48, v48
  v_exp_f32 v49, v49
  v_exp_f32 v50, v50
  v_exp_f32 v51, v51
  v_cvt_pk_bf16_f32 v72, v44, v45
  v_cvt_pk_bf16_f32 v73, v46, v47
  v_cvt_pk_bf16_f32 v74, v48, v49
  v_cvt_pk_bf16_f32 v75, v50, v51
  v_mfma_f32_32x32x16_bf16 v[224:239], v[116:119], v[68:71], v[224:239]
  v_exp_f32 v52, v52
  v_exp_f32 v53, v53
  v_exp_f32 v54, v54
  v_mfma_f32_32x32x16_bf16 v[224:239], v[120:123], v[72:75], v[224:239]
  v_exp_f32 v55, v55
  v_exp_f32 v56, v56
  v_exp_f32 v57, v57
  s_waitcnt vmcnt(6)
  v_mfma_f32_32x32x16_bf16 v[36:51], v[76:79], v[4:7], 0
  v_exp_f32 v58, v58
  v_exp_f32 v59, v59
  v_exp_f32 v60, v60
  v_exp_f32 v61, v61
  s_sub_u32 s67, s67, 1
  s_cmp_le_u32 s67, 1
  s_cselect_b64 vcc, 0, -1
  v_cvt_pk_bf16_f32 v68, v52, v53
  v_cvt_pk_bf16_f32 v69, v54, v55
  v_cvt_pk_bf16_f32 v70, v56, v57
  v_cvt_pk_bf16_f32 v71, v58, v59
  v_exp_f32 v62, v62
  v_exp_f32 v63, v63
  v_exp_f32 v64, v64
  v_exp_f32 v65, v65
  v_exp_f32 v66, v66
  v_exp_f32 v67, v67
  v_cvt_pk_bf16_f32 v72, v60, v61
  v_cvt_pk_bf16_f32 v73, v62, v63
  v_cvt_pk_bf16_f32 v74, v64, v65
  v_cvt_pk_bf16_f32 v75, v66, v67
  s_branch L_at_loop
L_at_last:
  v_mov_b32 v124, 0x10000
  s_mul_i32 s68, s60, 0x3600
  v_lshlrev_b32 v1, 2, v0
  v_add_u32 v88, s68, v2
  v_add_u32 v1, 0x800, v1
  v_add_u32 v89, s68, v1
  s_lshl_b32 s68, s60, 2
  s_add_u32 s68, s68, 0x10000
  v_mov_b32 v90, s68
  v_mov_b32 v91, 1
  s_xor_b32 s68, s60, 3
  s_mul_i32 s68, s68, 0x3600
  v_add_u32 v92, s68, v2
  v_add_u32 v95, s68, v1
  s_xor_b32 s68, s60, 2
  s_mul_i32 s68, s68, 0x3600
  v_add_u32 v93, s68, v2
  v_add_u32 v96, s68, v1
  s_xor_b32 s68, s60, 1
  s_mul_i32 s68, s68, 0x3600
  v_add_u32 v94, s68, v2
  v_add_u32 v97, s68, v1
  v_mov_b32 v126, s75
  v_mov_b32 v127, 0
  s_mov_b32 s3, 0
L_lw_xn:
  ds_read_b128 v[100:103], v124 offset:16
  s_add_u32 s3, s3, 1
  s_waitcnt lgkmcnt(0)
  v_and_b32 v100, v100, v101
  v_and_b32 v102, v102, v103
  v_and_b32 v100, v100, v102
  v_cmp_ne_u32 vcc, 1, v100
  s_cmp_gt_u32 s3, 0x200000
  s_cbranch_vccz L_lwd_xn
  s_cbranch_scc0 L_lw_xn
L_lwd_xn:
  v_exp_f32 v46, v46
  v_exp_f32 v47, v47
  v_exp_f32 v48, v48
  v_exp_f32 v49, v49
  v_exp_f32 v50, v50
  v_exp_f32 v51, v51
  v_cvt_pk_bf16_f32 v72, v44, v45
  v_cvt_pk_bf16_f32 v73, v46, v47
  v_cvt_pk_bf16_f32 v74, v48, v49
  v_cvt_pk_bf16_f32 v75, v50, v51
  v_mfma_f32_32x32x16_bf16 v[128:143], v[116:119], v[68:71], v[128:143]
  v_exp_f32 v52, v52
  v_exp_f32 v53, v53
  v_exp_f32 v54, v54
  v_mfma_f32_32x32x16_bf16 v[128:143], v[120:123], v[72:75], v[128:143]
  v_exp_f32 v55, v55
  v_exp_f32 v56, v56
  v_exp_f32 v57, v57
  v_mfma_f32_32x32x16_bf16 v[36:51], v[112:115], v[12:15], 0
  v_exp_f32 v58, v58
  v_exp_f32 v59, v59
  v_exp_f32 v60, v60
  v_exp_f32 v61, v61
  v_cvt_pk_bf16_f32 v68, v52, v53
  v_cvt_pk_bf16_f32 v69, v54, v55
  v_cvt_pk_bf16_f32 v70, v56, v57
  v_cvt_pk_bf16_f32 v71, v58, v59
  v_exp_f32 v62, v62
  v_exp_f32 v63, v63
  v_exp_f32 v64, v64
  v_exp_f32 v65, v65
  ds_write_b128 v88, v[128:131] offset:0
  v_exp_f32 v66, v66
  v_exp_f32 v67, v67
  v_cvt_pk_bf16_f32 v72, v60, v61
  ds_write_b128 v88, v[132:135] offset:1024
  v_cvt_pk_bf16_f32 v73, v62, v63
  v_cvt_pk_bf16_f32 v74, v64, v65
  v_cvt_pk_bf16_f32 v75, v66, v67
  v_mfma_f32_32x32x16_bf16 v[144:159], v[116:119], v[68:71], v[144:159]
  v_exp_f32 v36, v36
  v_exp_f32 v37, v37
  v_exp_f32 v38, v38
  v_mfma_f32_32x32x16_bf16 v[144:159], v[120:123], v[72:75], v[144:159]
  v_exp_f32 v39, v39
  v_exp_f32 v40, v40
  v_exp_f32 v41, v41
  v_mfma_f32_32x32x16_bf16 v[52:67], v[112:115], v[16:19], 0
  v_exp_f32 v42, v42
  v_exp_f32 v43, v43
  v_exp_f32 v44, v44
  v_exp_f32 v45, v45
  v_cvt_pk_bf16_f32 v68, v36, v37
  v_cvt_pk_bf16_f32 v69, v38, v39
  v_cvt_pk_bf16_f32 v70, v40, v41
  v_cvt_pk_bf16_f32 v71, v42, v43
  v_exp_f32 v46, v46
  v_exp_f32 v47, v47
  v_exp_f32 v48, v48
  v_exp_f32 v49, v49
  ds_write_b128 v88, v[144:147] offset:2304
  v_exp_f32 v50, v50
  v_exp_f32 v51, v51
  v_cvt_pk_bf16_f32 v72, v44, v45
  ds_write_b128 v88, v[148:151] offset:3328
  ds_write2st64_b32 v89, v136, v152 offset0:0 offset1:9
  v_cvt_pk_bf16_f32 v73, v46, v47
  v_cvt_pk_bf16_f32 v74, v48, v49
  v_cvt_pk_bf16_f32 v75, v50, v51
  v_mfma_f32_32x32x16_bf16 v[160:175], v[116:119], v[68:71], v[160:175]
  v_exp_f32 v52, v52
  v_exp_f32 v53, v53
  v_exp_f32 v54, v54
  v_mfma_f32_32x32x16_bf16 v[160:175], v[120:123], v[72:75], v[160:175]
  v_exp_f32 v55, v55
  v_exp_f32 v56, v56
  v_exp_f32 v57, v57
  v_mfma_f32_32x32x16_bf16 v[36:51], v[112:115], v[20:23], 0
  v_exp_f32 v58, v58
  v_exp_f32 v59, v59
  v_exp_f32 v60, v60
  v_exp_f32 v61, v61
  v_cvt_pk_bf16_f32 v68, v52, v53
  v_cvt_pk_bf16_f32 v69, v54, v55
  v_cvt_pk_bf16_f32 v70, v56, v57
  v_cvt_pk_bf16_f32 v71, v58, v59
  v_exp_f32 v62, v62
  v_exp_f32 v63, v63
  v_exp_f32 v64, v64
  v_exp_f32 v65, v65
  ds_write_b128 v88, v[160:163] offset:4608
  v_exp_f32 v66, v66
  v_exp_f32 v67, v67
  v_cvt_pk_bf16_f32 v72, v60, v61
  ds_write_b128 v88, v[164:167] offset:5632
  v_cvt_pk_bf16_f32 v73, v62, v63
  v_cvt_pk_bf16_f32 v74, v64, v65
  v_cvt_pk_bf16_f32 v75, v66, v67
  v_mfma_f32_32x32x16_bf16 v[176:191], v[116:119], v[68:71], v[176:191]
  v_exp_f32 v36, v36
  v_exp_f32 v37, v37
  v_exp_f32 v38, v38
  v_mfma_f32_32x32x16_bf16 v[176:191], v[120:123], v[72:75], v[176:191]
  v_exp_f32 v39, v39
  v_exp_f32 v40, v40
  v_exp_f32 v41, v41
  v_mfma_f32_32x32x16_bf16 v[52:67], v[112:115], v[24:27], 0
  v_exp_f32 v42, v42
  v_exp_f32 v43, v43
  v_exp_f32 v44, v44
  v_exp_f32 v45, v45
  v_cvt_pk_bf16_f32 v68, v36, v37
  v_cvt_pk_bf16_f32 v69, v38, v39
  v_cvt_pk_bf16_f32 v70, v40, v41
  v_cvt_pk_bf16_f32 v71, v42, v43
  v_exp_f32 v46, v46
  v_exp_f32 v47, v47
  v_exp_f32 v48, v48
  v_exp_f32 v49, v49
  ds_write_b128 v88, v[176:179] offset:6912
  v_exp_f32 v50, v50
  v_exp_f32 v51, v51
  v_cvt_pk_bf16_f32 v72, v44, v45
  ds_write_b128 v88, v[180:183] offset:7936
  ds_write2st64_b32 v89, v168, v184 offset0:18 offset1:27
  v_cvt_pk_bf16_f32 v73, v46, v47
  v_cvt_pk_bf16_f32 v74, v48, v49
  v_cvt_pk_bf16_f32 v75, v50, v51
  v_mfma_f32_32x32x16_bf16 v[192:207], v[116:119], v[68:71], v[192:207]
  v_exp_f32 v52, v52
  v_exp_f32 v53, v53
  v_exp_f32 v54, v54
  v_mfma_f32_32x32x16_bf16 v[192:207], v[120:123], v[72:75], v[192:207]
  v_exp_f32 v55, v55
  v_exp_f32 v56, v56
  v_exp_f32 v57, v57
  v_mfma_f32_32x32x16_bf16 v[36:51], v[112:115], v[28:31], 0
  v_exp_f32 v58, v58
  v_exp_f32 v59, v59
  v_exp_f32 v60, v60
  v_exp_f32 v61, v61
  v_cvt_pk_bf16_f32 v68, v52, v53
  v_cvt_pk_bf16_f32 v69, v54, v55
  v_cvt_pk_bf16_f32 v70, v56, v57
  v_cvt_pk_bf16_f32 v71, v58, v59
  v_exp_f32 v62, v62
  v_exp_f32 v63, v63
  v_exp_f32 v64, v64
  v_exp_f32 v65, v65
  ds_write_b128 v88, v[192:195] offset:9216
  v_exp_f32 v66, v66
  v_exp_f32 v67, v67
  v_cvt_pk_bf16_f32 v72, v60, v61
  ds_write_b128 v88, v[196:199] offset:10240
  v_cvt_pk_bf16_f32 v73, v62, v63
  v_cvt_pk_bf16_f32 v74, v64, v65
  v_cvt_pk_bf16_f32 v75, v66, v67
  v_mfma_f32_32x32x16_bf16 v[208:223], v[116:119], v[68:71], v[208:223]
  v_exp_f32 v36, v36
  v_exp_f32 v37, v37
  v_exp_f32 v38, v38
  v_mfma_f32_32x32x16_bf16 v[208:223], v[120:123], v[72:75], v[208:223]
  v_exp_f32 v39, v39
  v_exp_f32 v40, v40
  v_exp_f32 v41, v41
  v_mfma_f32_32x32x16_bf16 v[52:67], v[112:115], v[32:35], 0
  v_exp_f32 v42, v42
  v_exp_f32 v43, v43
  v_exp_f32 v44, v44
  v_exp_f32 v45, v45
  v_cvt_pk_bf16_f32 v68, v36, v37
  v_cvt_pk_bf16_f32 v69, v38, v39
  v_cvt_pk_bf16_f32 v70, v40, v41
  v_cvt_pk_bf16_f32 v71, v42, v43
  v_exp_f32 v46, v46
  v_exp_f32 v47, v47
  v_exp_f32 v48, v48
  v_exp_f32 v49, v49
  ds_write_b128 v88, v[208:211] offset:11520
  v_exp_f32 v50, v50
  v_exp_f32 v51, v51
  v_cvt_pk_bf16_f32 v72, v44, v45
  ds_write_b128 v88, v[212:215] offset:12544
  ds_write2st64_b32 v89, v200, v216 offset0:36 offset1:45
  v_cvt_pk_bf16_f32 v73, v46, v47
  v_cvt_pk_bf16_f32 v74, v48, v49
  v_cvt_pk_bf16_f32 v75, v50, v51
  v_mfma_f32_32x32x16_bf16 v[224:239], v[116:119], v[68:71], v[224:239]
  v_exp_f32 v52, v52
  v_exp_f32 v53, v53
  v_exp_f32 v54, v54
  v_mfma_f32_32x32x16_bf16 v[224:239], v[120:123], v[72:75], v[224:239]
  v_exp_f32 v55, v55
  v_exp_f32 v56, v56
  v_exp_f32 v57, v57
  s_waitcnt lgkmcnt(0)
  ds_write_b32 v90, v91
  v_exp_f32 v58, v58
  v_exp_f32 v59, v59
  v_exp_f32 v60, v60
  v_exp_f32 v61, v61
  v_cvt_pk_bf16_f32 v68, v52, v53
  v_cvt_pk_bf16_f32 v69, v54, v55
  v_cvt_pk_bf16_f32 v70, v56, v57
  v_cvt_pk_bf16_f32 v71, v58, v59
  v_exp_f32 v62, v62
  v_exp_f32 v63, v63
  v_exp_f32 v64, v64
  v_exp_f32 v65, v65
  v_exp_f32 v66, v66
  v_exp_f32 v67, v67
  v_cvt_pk_bf16_f32 v72, v60, v61
  v_cvt_pk_bf16_f32 v73, v62, v63
  v_cvt_pk_bf16_f32 v74, v64, v65
  v_cvt_pk_bf16_f32 v75, v66, v67
  s_nop 0
  v_mfma_f32_32x32x16_bf16 v[240:255], v[116:119], v[68:71], v[240:255]
  v_mfma_f32_32x32x16_bf16 v[240:255], v[120:123], v[72:75], v[240:255]
  s_mov_b32 s3, 0
L_lw_pair:
  ds_read_b128 v[100:103], v124 offset:0
  s_add_u32 s3, s3, 1
  s_waitcnt lgkmcnt(0)
  v_and_b32 v100, v100, v101
  v_and_b32 v102, v102, v103
  v_and_b32 v100, v100, v102
  v_cmp_ne_u32 vcc, 1, v100
  s_cmp_gt_u32 s3, 0x200000
  s_cbranch_vccz L_lwd_pair
  s_cbranch_scc0 L_lw_pair
L_lwd_pair:
  ds_read2st64_b32 v[104:105], v95 offset0:0 offset1:9
  ds_read_b128 v[128:131], v92 offset:0
  ds_read_b128 v[132:135], v92 offset:1024
  ds_read_b128 v[144:147], v92 offset:2304
  ds_read_b128 v[148:151], v92 offset:3328
  ds_read2st64_b32 v[106:107], v96 offset0:18 offset1:27
  ds_read_b128 v[160:163], v93 offset:4608
  ds_read_b128 v[164:167], v93 offset:5632
  ds_read_b128 v[176:179], v93 offset:6912
  ds_read_b128 v[180:183], v93 offset:7936
  ds_read2st64_b32 v[108:109], v97 offset0:36 offset1:45
  ds_read_b128 v[192:195], v94 offset:9216
  ds_read_b128 v[196:199], v94 offset:10240
  ds_read_b128 v[208:211], v94 offset:11520
  ds_read_b128 v[212:215], v94 offset:12544
  s_waitcnt lgkmcnt(10)
  v_add_f32 v232, v232, v104
  v_add_f32 v248, v248, v105
  v_pk_add_f32 v[224:225], v[224:225], v[128:129]
  v_pk_add_f32 v[226:227], v[226:227], v[130:131]
  v_pk_add_f32 v[228:229], v[228:229], v[132:133]
  v_pk_add_f32 v[230:231], v[230:231], v[134:135]
  v_pk_add_f32 v[240:241], v[240:241], v[144:145]
  v_pk_add_f32 v[242:243], v[242:243], v[146:147]
  v_pk_add_f32 v[244:245], v[244:245], v[148:149]
  v_pk_add_f32 v[246:247], v[246:247], v[150:151]
  s_waitcnt lgkmcnt(5)
  v_add_f32 v232, v232, v106
  v_add_f32 v248, v248, v107
  v_pk_add_f32 v[224:225], v[224:225], v[160:161]
  v_pk_add_f32 v[226:227], v[226:227], v[162:163]
  v_pk_add_f32 v[228:229], v[228:229], v[164:165]
  v_pk_add_f32 v[230:231], v[230:231], v[166:167]
  v_pk_add_f32 v[240:241], v[240:241], v[176:177]
  v_pk_add_f32 v[242:243], v[242:243], v[178:179]
  v_pk_add_f32 v[244:245], v[244:245], v[180:181]
  v_pk_add_f32 v[246:247], v[246:247], v[182:183]
  s_waitcnt lgkmcnt(0)
  v_add_f32 v232, v232, v108
  v_add_f32 v248, v248, v109
  v_pk_add_f32 v[224:225], v[224:225], v[192:193]
  v_pk_add_f32 v[226:227], v[226:227], v[194:195]
  v_pk_add_f32 v[228:229], v[228:229], v[196:197]
  v_pk_add_f32 v[230:231], v[230:231], v[198:199]
  v_pk_add_f32 v[240:241], v[240:241], v[208:209]
  v_pk_add_f32 v[242:243], v[242:243], v[210:211]
  v_pk_add_f32 v[244:245], v[244:245], v[212:213]
  v_pk_add_f32 v[246:247], v[246:247], v[214:215]
  v_subrev_u32 v40, 0x12800000, v232
  v_subrev_u32 v41, 0x12800000, v248
  v_pk_mul_f32 v[42:43], v[224:225], 0 op_sel_hi:[1,0]
  v_max_u32 v40, v40, v41
  v_pk_fma_f32 v[42:43], v[226:227], 0, v[42:43] op_sel_hi:[1,0,1]
  v_pk_fma_f32 v[42:43], v[228:229], 0, v[42:43] op_sel_hi:[1,0,1]
  v_pk_fma_f32 v[42:43], v[230:231], 0, v[42:43] op_sel_hi:[1,0,1]
  v_pk_fma_f32 v[42:43], v[240:241], 0, v[42:43] op_sel_hi:[1,0,1]
  v_pk_fma_f32 v[42:43], v[242:243], 0, v[42:43] op_sel_hi:[1,0,1]
  v_pk_fma_f32 v[42:43], v[244:245], 0, v[42:43] op_sel_hi:[1,0,1]
  v_pk_fma_f32 v[42:43], v[246:247], 0, v[42:43] op_sel_hi:[1,0,1]
  v_cmp_lt_u32 vcc, 0x69000000, v40
  v_cmp_u_f32 s[68:69], v42, v43
  s_nop 0
  s_or_b64 vcc, vcc, s[68:69]
  s_cbranch_vccnz L_at_slow
L_at_norm:
  v_rcp_f32 v40, v232
  v_rcp_f32 v41, v248
  s_nop 0
  v_mul_f32 v224, v224, v40
  v_mul_f32 v225, v225, v40
  v_mul_f32 v226, v226, v40
  v_mul_f32 v227, v227, v40
  v_mul_f32 v228, v228, v40
  v_mul_f32 v229, v229, v40
  v_mul_f32 v230, v230, v40
  v_mul_f32 v231, v231, v40
  v_cvt_pk_bf16_f32 v44, v224, v225
  v_cvt_pk_bf16_f32 v45, v226, v227
  v_cvt_pk_bf16_f32 v46, v228, v229
  v_cvt_pk_bf16_f32 v47, v230, v231
  buffer_store_dwordx4 v[44:47], v2, s[52:55], s6 offen sc1
  v_mul_f32 v240, v240, v41
  v_mul_f32 v241, v241, v41
  v_mul_f32 v242, v242, v41
  v_mul_f32 v243, v243, v41
  v_mul_f32 v244, v244, v41
  v_mul_f32 v245, v245, v41
  v_mul_f32 v246, v246, v41
  v_mul_f32 v247, v247, v41
  v_cvt_pk_bf16_f32 v48, v240, v241
  v_cvt_pk_bf16_f32 v49, v242, v243
  v_cvt_pk_bf16_f32 v50, v244, v245
  v_cvt_pk_bf16_f32 v51, v246, v247
  buffer_store_dwordx4 v[48:51], v2, s[52:55], s7 offen sc1
  s_waitcnt vmcnt(0)
  s_mov_b64 exec, 1
  buffer_store_dword v126, v127, s[52:55], s8 offen sc1
  s_mov_b64 exec, -1
L_end:
  s_endpgm
L_kvs_8:
  s_waitcnt vmcnt(3)
  s_branch L_kvr_8
L_kvs_16:
  s_waitcnt vmcnt(0)
  s_branch L_kvr_16
.p2align 6
L_gemm:
  s_lshr_b32 s68, s10, 3
  s_lshl2_add_u32 s65, s3, s68
  s_and_b32 s66, s10, 7
  s_add_u32 s9, s68, s66
  s_and_b32 s9, s9, 3
  v_lshrrev_b32 v1, 5, v0
  v_lshlrev_b32 v10, 4, v0
  s_and_b32 s68, s60, 1
  s_lshl_b32 s20, s68, 15
  v_xor_b32 v3, v0, v1
  v_xor_b32 v15, 0, v3
  v_lshlrev_b32 v15, 4, v15
  v_add_u32 v15, 0x0, v15
  v_add_u32 v4, s20, v15
  v_xor_b32 v15, 2, v3
  v_lshlrev_b32 v15, 4, v15
  v_add_u32 v15, 0x400, v15
  v_add_u32 v5, s20, v15
  v_xor_b32 v15, 4, v3
  v_lshlrev_b32 v15, 4, v15
  v_add_u32 v15, 0x800, v15
  v_add_u32 v6, s20, v15
  v_xor_b32 v15, 6, v3
  v_lshlrev_b32 v15, 4, v15
  v_add_u32 v15, 0xc00, v15
  v_add_u32 v7, s20, v15
  v_bfe_u32 v104, v0, 2, 2
  v_bfe_u32 v105, v0, 3, 1
  v_bfe_u32 v106, v0, 4, 1
  v_and_b32 v107, 3, v0
  v_lshlrev_b32 v107, 3, v107
  v_lshl_add_u32 v108, v1, 3, v104
  v_lshl_add_u32 v108, v108, 7, v107
  v_lshl_add_u32 v107, v106, 5, v107
  s_lshr_b32 s69, s60, 1
  v_xor_b32 v3, s69, v105
  v_lshl_add_u32 v3, v3, 6, v108
  v_lshl_add_u32 v3, v106, 5, v3
  v_add_u32 v8, 0x10000, v3
  v_add_u32 v9, 0x1c000, v3
  s_lshl1_add_u32 s71, s61, s68
  s_and_b32 s72, s60, 2
  s_lshl2_add_u32 s72, s62, s72
  s_lshl_b32 s73, s72, 6
  s_add_u32 s73, s73, s71
  s_lshl_b32 s4, s73, 10
  s_add_u32 s4, s4, 0x100000
  s_add_u32 s5, s4, 0x10000
  s_lshl_b32 s6, s73, 11
  s_add_u32 s6, s6, 0x300000
  s_add_u32 s7, s6, 0x20000
  s_lshl_b32 s8, s62, 5
  s_add_u32 s8, s8, s61
  s_lshl_b32 s8, s8, 7
  s_add_u32 s8, s8, 0x40000
  v_lshlrev_b32 v3, 17, v106
  v_lshl_add_u32 v3, v1, 8, v3
  v_and_b32 v15, 15, v0
  v_lshl_add_u32 v11, v15, 4, v3
  s_lshl_b32 s14, s60, 14
  s_add_u32 s14, s14, 0x10100
  s_mov_b32 s63, s62
  s_lshl2_add_u32 s71, s63, s60
  s_lshl_b32 s72, s71, 7
  v_mul_u32_u24 v3, 0xe00, v2
  v_add_u32 v3, s72, v3
  v_lshlrev_b32 v15, 1, v106
  v_xor_b32 v15, v15, v0
  v_and_b32 v15, 7, v15
  v_lshl_add_u32 v116, v15, 4, v3
  v_xor_b32 v15, 4, v15
  v_lshl_add_u32 v118, v15, 4, v3
  v_add_u32 v117, 0x6c00, v116
  v_add_u32 v119, 0x6c00, v118
  v_lshl_add_u32 v3, v106, 11, v108
  v_add_u32 v3, s14, v3
  v_lshl_add_u32 v109, v106, 1, v105
  v_xor_b32 v15, 0, v109
  v_lshl_add_u32 v112, v15, 5, v3
  v_xor_b32 v15, 1, v109
  v_lshl_add_u32 v113, v15, 5, v3
  v_xor_b32 v15, 2, v109
  v_lshl_add_u32 v114, v15, 5, v3
  v_xor_b32 v15, 3, v109
  v_lshl_add_u32 v115, v15, 5, v3
  s_mul_i32 s72, s61, 224
  s_lshl2_add_u32 s12, s71, s72
  s_lshl_b32 s12, s12, 10
  s_add_u32 s12, s12, 0x900000
  s_add_u32 s13, s12, 0x1c000
  s_lshl_b32 s15, s61, 5
  s_add_u32 s15, s15, s71
  s_lshl_b32 s15, s15, 7
  s_add_u32 s15, s15, 0x60000
  s_mul_i32 s71, s69, 0x1c000
  v_add_u32 v120, s71, v10
  s_xor_b32 s71, s71, 0x1c000
  v_add_u32 v121, s71, v10
  s_mul_i32 s56, s65, 0x38000
  s_mul_i32 s71, s60, 0x7000
  s_add_u32 s56, s56, s71
  s_add_u32 s56, s56, 0x900000
  s_mul_i32 s57, s60, 0x70000
  s_add_u32 s59, s57, 0x70000
  s_add_u32 s58, s56, 0x7000
  s_mul_i32 s19, s9, 0x1c000
  s_add_u32 s19, s19, s57
  s_mul_i32 s18, s9, 0x1c00
  s_add_u32 s18, s18, s56
  v_lshl_add_u32 v3, v1, 2, v104
  v_lshl_add_u32 v3, v3, 7, v107
  v_add_u32 v3, s14, v3
  v_xor_b32 v15, s68, v105
  v_lshl_add_u32 v122, v15, 6, v3
  v_xor_b32 v15, 1, v15
  v_lshl_add_u32 v123, v15, 6, v3
  v_lshlrev_b32 v3, 10, v2
  v_lshl_add_u32 v3, v12, 4, v3
  s_lshl_b32 s71, s66, 7
  v_add_u32 v124, s71, v3
  v_add_u32 v125, 0x1c00, v124
  v_and_b32 v3, 31, v0
  v_lshlrev_b32 v3, 10, v3
  v_lshl_add_u32 v126, v1, 3, v3
  v_lshl_add_u32 v127, v1, 4, v3
  s_lshl_b32 s71, s69, 6
  s_add_u32 s71, s71, s68
  s_lshl_b32 s71, s71, 6
  s_add_u32 s71, s71, 0x10100
  v_lshrrev_b32 v3, 3, v3
  v_lshl_add_u32 v3, v1, 3, v3
  v_add_u32 v126, s71, v3
  s_lshl1_add_u32 s71, s65, s69
  s_lshl1_add_u32 s72, s66, s68
  s_lshl_b32 s71, s71, 15
  s_lshl_b32 s72, s72, 6
  s_add_u32 s74, s71, s72
  s_mul_i32 s71, s60, 7
  s_lshl_b32 s16, s65, 5
  s_add_u32 s16, s16, s71
  s_lshl_b32 s16, s16, 7
  s_add_u32 s16, s16, 0x60000
  s_lshl2_add_u32 s17, s65, s60
  s_lshl_b32 s17, s17, 10
  s_add_u32 s17, s17, 0x80000
  s_mov_b32 s73, 0x3eb8aa3b
  s_setprio 1
  s_waitcnt vmcnt(6) lgkmcnt(0)
  s_mul_i32 s75, s75, 0x19660d
  s_add_u32 s75, s75, 0x3c6ef35f
  v_mov_b32 v110, s75
  v_mov_b32 v111, 0
  s_barrier
  ds_read_b128 v[140:143], v4 offset:0
  ds_read_b64_tr_b16 v[128:129], v8 offset:0
  ds_read_b64_tr_b16 v[130:131], v8 offset:512
  ds_read_b64_tr_b16 v[132:133], v8 offset:2048
  ds_read_b64_tr_b16 v[134:135], v8 offset:2560
  ds_read_b64_tr_b16 v[136:137], v8 offset:4096
  ds_read_b64_tr_b16 v[138:139], v8 offset:4608
  ds_read_b128 v[156:159], v5 offset:0
  ds_read_b64_tr_b16 v[144:145], v8 offset:6144
  ds_read_b64_tr_b16 v[146:147], v8 offset:6656
  ds_read_b64_tr_b16 v[148:149], v8 offset:8192
  ds_read_b64_tr_b16 v[150:151], v8 offset:8704
  ds_read_b64_tr_b16 v[152:153], v8 offset:10240
  ds_read_b64_tr_b16 v[154:155], v8 offset:10752
  s_waitcnt lgkmcnt(7)
  v_mfma_f32_32x32x16_bf16 v[32:47], v[132:135], v[140:143], 0
  ds_read_b128 v[172:175], v6 offset:0
  ds_read_b64_tr_b16 v[160:161], v8 offset:12288
  ds_read_b64_tr_b16 v[162:163], v8 offset:12800
  ds_read_b64_tr_b16 v[164:165], v8 offset:14336
  v_mfma_f32_32x32x16_bf16 v[16:31], v[128:131], v[140:143], 0
  ds_read_b64_tr_b16 v[166:167], v8 offset:14848
  ds_read_b64_tr_b16 v[168:169], v8 offset:16384
  ds_read_b64_tr_b16 v[170:171], v8 offset:16896
  v_mfma_f32_32x32x16_bf16 v[48:63], v[140:143], v[136:139], 0
  s_waitcnt lgkmcnt(7)
  v_mfma_f32_32x32x16_bf16 v[32:47], v[148:151], v[156:159], v[32:47]
  ds_read_b128 v[140:143], v7 offset:0
  ds_read_b64_tr_b16 v[128:129], v8 offset:18432
  ds_read_b64_tr_b16 v[130:131], v8 offset:18944
  ds_read_b64_tr_b16 v[132:133], v8 offset:20480
  v_mfma_f32_32x32x16_bf16 v[16:31], v[144:147], v[156:159], v[16:31]
  ds_read_b64_tr_b16 v[134:135], v8 offset:20992
  ds_read_b64_tr_b16 v[136:137], v8 offset:22528
  ds_read_b64_tr_b16 v[138:139], v8 offset:23040
  v_mfma_f32_32x32x16_bf16 v[48:63], v[156:159], v[152:155], v[48:63]
  s_waitcnt vmcnt(0) lgkmcnt(7)
  s_barrier
  v_mfma_f32_32x32x16_bf16 v[32:47], v[164:167], v[172:175], v[32:47]
  ds_read_b128 v[156:159], v4 offset:4096
  ds_read_b64_tr_b16 v[144:145], v8 offset:24576
  ds_read_b64_tr_b16 v[146:147], v8 offset:25088
  ds_read_b64_tr_b16 v[148:149], v8 offset:26624
  v_mfma_f32_32x32x16_bf16 v[16:31], v[160:163], v[172:175], v[16:31]
  ds_read_b64_tr_b16 v[150:151], v8 offset:27136
  ds_read_b64_tr_b16 v[152:153], v8 offset:28672
  ds_read_b64_tr_b16 v[154:155], v8 offset:29184
  v_mfma_f32_32x32x16_bf16 v[48:63], v[172:175], v[168:171], v[48:63]
  s_waitcnt lgkmcnt(7)
  v_mfma_f32_32x32x16_bf16 v[32:47], v[132:135], v[140:143], v[32:47]
  ds_read_b128 v[172:175], v5 offset:4096
  ds_read_b64_tr_b16 v[160:161], v8 offset:30720
  ds_read_b64_tr_b16 v[162:163], v8 offset:31232
  ds_read_b64_tr_b16 v[164:165], v8 offset:32768
  v_mfma_f32_32x32x16_bf16 v[16:31], v[128:131], v[140:143], v[16:31]
  ds_read_b64_tr_b16 v[166:167], v8 offset:33280
  ds_read_b64_tr_b16 v[168:169], v8 offset:34816
  ds_read_b64_tr_b16 v[170:171], v8 offset:35328
  v_mfma_f32_32x32x16_bf16 v[48:63], v[140:143], v[136:139], v[48:63]
  s_waitcnt lgkmcnt(7)
  v_mfma_f32_32x32x16_bf16 v[32:47], v[148:151], v[156:159], v[32:47]
  ds_read_b128 v[140:143], v6 offset:4096
  ds_read_b64_tr_b16 v[128:129], v8 offset:36864
  ds_read_b64_tr_b16 v[130:131], v8 offset:37376
  ds_read_b64_tr_b16 v[132:133], v8 offset:38912
  v_mfma_f32_32x32x16_bf16 v[16:31], v[144:147], v[156:159], v[16:31]
  ds_read_b64_tr_b16 v[134:135], v8 offset:39424
  ds_read_b64_tr_b16 v[136:137], v8 offset:40960
  ds_read_b64_tr_b16 v[138:139], v8 offset:41472
  v_mfma_f32_32x32x16_bf16 v[48:63], v[156:159], v[152:155], v[48:63]
  s_waitcnt lgkmcnt(7)
  v_mfma_f32_32x32x16_bf16 v[32:47], v[164:167], v[172:175], v[32:47]
  ds_read_b128 v[156:159], v7 offset:4096
  ds_read_b64_tr_b16 v[144:145], v8 offset:43008
  ds_read_b64_tr_b16 v[146:147], v8 offset:43520
  ds_read_b64_tr_b16 v[148:149], v8 offset:45056
  v_mfma_f32_32x32x16_bf16 v[16:31], v[160:163], v[172:175], v[16:31]
  ds_read_b64_tr_b16 v[150:151], v8 offset:45568
  ds_read_b64_tr_b16 v[152:153], v8 offset:47104
  ds_read_b64_tr_b16 v[154:155], v8 offset:47616
  v_mfma_f32_32x32x16_bf16 v[48:63], v[172:175], v[168:171], v[48:63]
  s_waitcnt vmcnt(0) lgkmcnt(7)
  s_barrier
  v_mfma_f32_32x32x16_bf16 v[32:47], v[132:135], v[140:143], v[32:47]
  ds_read_b128 v[172:175], v4 offset:8192
  ds_read_b64_tr_b16 v[160:161], v9 offset:0
  ds_read_b64_tr_b16 v[162:163], v9 offset:512
  ds_read_b64_tr_b16 v[164:165], v9 offset:2048
  v_mfma_f32_32x32x16_bf16 v[16:31], v[128:131], v[140:143], v[16:31]
  ds_read_b64_tr_b16 v[166:167], v9 offset:2560
  ds_read_b64_tr_b16 v[168:169], v9 offset:4096
  ds_read_b64_tr_b16 v[170:171], v9 offset:4608
  v_mfma_f32_32x32x16_bf16 v[48:63], v[140:143], v[136:139], v[48:63]
  s_waitcnt lgkmcnt(7)
  v_mfma_f32_32x32x16_bf16 v[32:47], v[148:151], v[156:159], v[32:47]
  ds_read_b128 v[140:143], v5 offset:8192
  ds_read_b64_tr_b16 v[128:129], v9 offset:6144
  ds_read_b64_tr_b16 v[130:131], v9 offset:6656
  ds_read_b64_tr_b16 v[132:133], v9 offset:8192
  v_mfma_f32_32x32x16_bf16 v[16:31], v[144:147], v[156:159], v[16:31]
  ds_read_b64_tr_b16 v[134:135], v9 offset:8704
  ds_read_b64_tr_b16 v[136:137], v9 offset:10240
  ds_read_b64_tr_b16 v[138:139], v9 offset:10752
  v_mfma_f32_32x32x16_bf16 v[48:63], v[156:159], v[152:155], v[48:63]
  s_waitcnt lgkmcnt(7)
  v_mfma_f32_32x32x16_bf16 v[32:47], v[164:167], v[172:175], v[32:47]
  ds_read_b128 v[156:159], v6 offset:8192
  ds_read_b64_tr_b16 v[144:145], v9 offset:12288
  ds_read_b64_tr_b16 v[146:147], v9 offset:12800
  ds_read_b64_tr_b16 v[148:149], v9 offset:14336
  v_mfma_f32_32x32x16_bf16 v[16:31], v[160:163], v[172:175], v[16:31]
  ds_read_b64_tr_b16 v[150:151], v9 offset:14848
  ds_read_b64_tr_b16 v[152:153], v9 offset:16384
  ds_read_b64_tr_b16 v[154:155], v9 offset:16896
  v_mfma_f32_32x32x16_bf16 v[48:63], v[172:175], v[168:171], v[48:63]
  s_waitcnt lgkmcnt(7)
  v_mfma_f32_32x32x16_bf16 v[32:47], v[132:135], v[140:143], v[32:47]
  ds_read_b128 v[172:175], v7 offset:8192
  ds_read_b64_tr_b16 v[160:161], v9 offset:18432
  ds_read_b64_tr_b16 v[162:163], v9 offset:18944
  ds_read_b64_tr_b16 v[164:165], v9 offset:20480
  v_mfma_f32_32x32x16_bf16 v[16:31], v[128:131], v[140:143], v[16:31]
  ds_read_b64_tr_b16 v[166:167], v9 offset:20992
  ds_read_b64_tr_b16 v[168:169], v9 offset:22528
  ds_read_b64_tr_b16 v[170:171], v9 offset:23040
  v_mfma_f32_32x32x16_bf16 v[48:63], v[140:143], v[136:139], v[48:63]
  s_waitcnt vmcnt(0) lgkmcnt(7)
  s_barrier
  v_mfma_f32_32x32x16_bf16 v[32:47], v[148:151], v[156:159], v[32:47]
  ds_read_b128 v[140:143], v4 offset:12288
  ds_read_b64_tr_b16 v[128:129], v9 offset:24576
  ds_read_b64_tr_b16 v[130:131], v9 offset:25088
  ds_read_b64_tr_b16 v[132:133], v9 offset:26624
  v_mfma_f32_32x32x16_bf16 v[16:31], v[144:147], v[156:159], v[16:31]
  ds_read_b64_tr_b16 v[134:135], v9 offset:27136
  ds_read_b64_tr_b16 v[136:137], v9 offset:28672
  ds_read_b64_tr_b16 v[138:139], v9 offset:29184
  v_mfma_f32_32x32x16_bf16 v[48:63], v[156:159], v[152:155], v[48:63]
  s_waitcnt lgkmcnt(7)
  v_mfma_f32_32x32x16_bf16 v[32:47], v[164:167], v[172:175], v[32:47]
  ds_read_b128 v[156:159], v5 offset:12288
  ds_read_b64_tr_b16 v[144:145], v9 offset:30720
  ds_read_b64_tr_b16 v[146:147], v9 offset:31232
  ds_read_b64_tr_b16 v[148:149], v9 offset:32768
  v_mfma_f32_32x32x16_bf16 v[16:31], v[160:163], v[172:175], v[16:31]
  ds_read_b64_tr_b16 v[150:151], v9 offset:33280
  ds_read_b64_tr_b16 v[152:153], v9 offset:34816
  ds_read_b64_tr_b16 v[154:155], v9 offset:35328
  v_mfma_f32_32x32x16_bf16 v[48:63], v[172:175], v[168:171], v[48:63]
  s_waitcnt lgkmcnt(7)
  v_mfma_f32_32x32x16_bf16 v[32:47], v[132:135], v[140:143], v[32:47]
  ds_read_b128 v[172:175], v6 offset:12288
  ds_read_b64_tr_b16 v[160:161], v9 offset:36864
  ds_read_b64_tr_b16 v[162:163], v9 offset:37376
  ds_read_b64_tr_b16 v[164:165], v9 offset:38912
  v_mfma_f32_32x32x16_bf16 v[16:31], v[128:131], v[140:143], v[16:31]
  ds_read_b64_tr_b16 v[166:167], v9 offset:39424
  ds_read_b64_tr_b16 v[168:169], v9 offset:40960
  ds_read_b64_tr_b16 v[170:171], v9 offset:41472
  v_mfma_f32_32x32x16_bf16 v[48:63], v[140:143], v[136:139], v[48:63]
  s_waitcnt lgkmcnt(7)
  v_mfma_f32_32x32x16_bf16 v[32:47], v[148:151], v[156:159], v[32:47]
  ds_read_b128 v[140:143], v7 offset:12288
  ds_read_b64_tr_b16 v[128:129], v9 offset:43008
  ds_read_b64_tr_b16 v[130:131], v9 offset:43520
  ds_read_b64_tr_b16 v[132:133], v9 offset:45056
  v_mfma_f32_32x32x16_bf16 v[16:31], v[144:147], v[156:159], v[16:31]
  ds_read_b64_tr_b16 v[134:135], v9 offset:45568
  ds_read_b64_tr_b16 v[136:137], v9 offset:47104
  ds_read_b64_tr_b16 v[138:139], v9 offset:47616
  v_mfma_f32_32x32x16_bf16 v[48:63], v[156:159], v[152:155], v[48:63]
  s_waitcnt vmcnt(0) lgkmcnt(7)
  s_barrier
  v_mfma_f32_32x32x16_bf16 v[32:47], v[164:167], v[172:175], v[32:47]
  ds_read_b128 v[156:159], v4 offset:16384
  ds_read_b64_tr_b16 v[144:145], v8 offset:0
  ds_read_b64_tr_b16 v[146:147], v8 offset:512
  ds_read_b64_tr_b16 v[148:149], v8 offset:2048
  v_mfma_f32_32x32x16_bf16 v[16:31], v[160:163], v[172:175], v[16:31]
  ds_read_b64_tr_b16 v[150:151], v8 offset:2560
  ds_read_b64_tr_b16 v[152:153], v8 offset:4096
  ds_read_b64_tr_b16 v[154:155], v8 offset:4608
  v_mfma_f32_32x32x16_bf16 v[48:63], v[172:175], v[168:171], v[48:63]
  s_waitcnt lgkmcnt(7)
  v_mfma_f32_32x32x16_bf16 v[32:47], v[132:135], v[140:143], v[32:47]
  ds_read_b128 v[172:175], v5 offset:16384
  ds_read_b64_tr_b16 v[160:161], v8 offset:6144
  ds_read_b64_tr_b16 v[162:163], v8 offset:6656
  ds_read_b64_tr_b16 v[164:165], v8 offset:8192
  v_mfma_f32_32x32x16_bf16 v[16:31], v[128:131], v[140:143], v[16:31]
  ds_read_b64_tr_b16 v[166:167], v8 offset:8704
  ds_read_b64_tr_b16 v[168:169], v8 offset:10240
  ds_read_b64_tr_b16 v[170:171], v8 offset:10752
  v_mfma_f32_32x32x16_bf16 v[48:63], v[140:143], v[136:139], v[48:63]
  s_waitcnt lgkmcnt(7)
  v_mfma_f32_32x32x16_bf16 v[32:47], v[148:151], v[156:159], v[32:47]
  ds_read_b128 v[140:143], v6 offset:16384
  ds_read_b64_tr_b16 v[128:129], v8 offset:12288
  ds_read_b64_tr_b16 v[130:131], v8 offset:12800
  ds_read_b64_tr_b16 v[132:133], v8 offset:14336
  v_mfma_f32_32x32x16_bf16 v[16:31], v[144:147], v[156:159], v[16:31]
  ds_read_b64_tr_b16 v[134:135], v8 offset:14848
  ds_read_b64_tr_b16 v[136:137], v8 offset:16384
  ds_read_b64_tr_b16 v[138:139], v8 offset:16896
  v_mfma_f32_32x32x16_bf16 v[48:63], v[156:159], v[152:155], v[48:63]
  s_waitcnt lgkmcnt(7)
  v_mfma_f32_32x32x16_bf16 v[32:47], v[164:167], v[172:175], v[32:47]
  ds_read_b128 v[156:159], v7 offset:16384
  ds_read_b64_tr_b16 v[144:145], v8 offset:18432
  ds_read_b64_tr_b16 v[146:147], v8 offset:18944
  ds_read_b64_tr_b16 v[148:149], v8 offset:20480
  v_mfma_f32_32x32x16_bf16 v[16:31], v[160:163], v[172:175], v[16:31]
  ds_read_b64_tr_b16 v[150:151], v8 offset:20992
  ds_read_b64_tr_b16 v[152:153], v8 offset:22528
  ds_read_b64_tr_b16 v[154:155], v8 offset:23040
  v_mfma_f32_32x32x16_bf16 v[48:63], v[172:175], v[168:171], v[48:63]
  s_waitcnt vmcnt(0) lgkmcnt(7)
  s_barrier
  v_mfma_f32_32x32x16_bf16 v[32:47], v[132:135], v[140:143], v[32:47]
  ds_read_b128 v[172:175], v4 offset:20480
  ds_read_b64_tr_b16 v[160:161], v8 offset:24576
  ds_read_b64_tr_b16 v[162:163], v8 offset:25088
  ds_read_b64_tr_b16 v[164:165], v8 offset:26624
  v_mfma_f32_32x32x16_bf16 v[16:31], v[128:131], v[140:143], v[16:31]
  ds_read_b64_tr_b16 v[166:167], v8 offset:27136
  ds_read_b64_tr_b16 v[168:169], v8 offset:28672
  ds_read_b64_tr_b16 v[170:171], v8 offset:29184
  v_mfma_f32_32x32x16_bf16 v[48:63], v[140:143], v[136:139], v[48:63]
  s_waitcnt lgkmcnt(7)
  v_mfma_f32_32x32x16_bf16 v[32:47], v[148:151], v[156:159], v[32:47]
  ds_read_b128 v[140:143], v5 offset:20480
  ds_read_b64_tr_b16 v[128:129], v8 offset:30720
  ds_read_b64_tr_b16 v[130:131], v8 offset:31232
  ds_read_b64_tr_b16 v[132:133], v8 offset:32768
  v_mfma_f32_32x32x16_bf16 v[16:31], v[144:147], v[156:159], v[16:31]
  ds_read_b64_tr_b16 v[134:135], v8 offset:33280
  ds_read_b64_tr_b16 v[136:137], v8 offset:34816
  ds_read_b64_tr_b16 v[138:139], v8 offset:35328
  v_mfma_f32_32x32x16_bf16 v[48:63], v[156:159], v[152:155], v[48:63]
  s_waitcnt lgkmcnt(7)
  v_mfma_f32_32x32x16_bf16 v[32:47], v[164:167], v[172:175], v[32:47]
  ds_read_b128 v[176:179], v6 offset:20480
  ds_read_b64_tr_b16 v[180:181], v8 offset:36864
  ds_read_b64_tr_b16 v[182:183], v8 offset:37376
  ds_read_b64_tr_b16 v[148:149], v8 offset:38912
  v_mfma_f32_32x32x16_bf16 v[16:31], v[160:163], v[172:175], v[16:31]
  ds_read_b64_tr_b16 v[150:151], v8 offset:39424
  ds_read_b64_tr_b16 v[152:153], v8 offset:40960
  ds_read_b64_tr_b16 v[154:155], v8 offset:41472
  v_mfma_f32_32x32x16_bf16 v[48:63], v[172:175], v[168:171], v[48:63]
  s_waitcnt lgkmcnt(7)
  v_mfma_f32_32x32x16_bf16 v[32:47], v[132:135], v[140:143], v[32:47]
  ds_read_b128 v[184:187], v7 offset:20480
  ds_read_b64_tr_b16 v[188:189], v8 offset:43008
  ds_read_b64_tr_b16 v[190:191], v8 offset:43520
  ds_read_b64_tr_b16 v[164:165], v8 offset:45056
  v_mfma_f32_32x32x16_bf16 v[16:31], v[128:131], v[140:143], v[16:31]
  ds_read_b64_tr_b16 v[166:167], v8 offset:45568
  ds_read_b64_tr_b16 v[168:169], v8 offset:47104
  ds_read_b64_tr_b16 v[170:171], v8 offset:47616
  v_mfma_f32_32x32x16_bf16 v[48:63], v[140:143], v[136:139], v[48:63]
  s_waitcnt vmcnt(0) lgkmcnt(7)
  s_barrier
  v_mfma_f32_32x32x16_bf16 v[32:47], v[148:151], v[176:179], v[32:47]
  ds_read_b128 v[192:195], v4 offset:24576
  ds_read_b64_tr_b16 v[196:197], v9 offset:0
  ds_read_b64_tr_b16 v[198:199], v9 offset:512
  ds_read_b64_tr_b16 v[132:133], v9 offset:2048
  v_mfma_f32_32x32x16_bf16 v[48:63], v[176:179], v[152:155], v[48:63]
  ds_read_b64_tr_b16 v[134:135], v9 offset:2560
  ds_read_b64_tr_b16 v[136:137], v9 offset:4096
  ds_read_b64_tr_b16 v[138:139], v9 offset:4608
  s_waitcnt lgkmcnt(7)
  v_mfma_f32_32x32x16_bf16 v[32:47], v[164:167], v[184:187], v[32:47]
  ds_read_b128 v[200:203], v5 offset:24576
  ds_read_b64_tr_b16 v[204:205], v9 offset:6144
  ds_read_b64_tr_b16 v[206:207], v9 offset:6656
  ds_read_b64_tr_b16 v[148:149], v9 offset:8192
  v_mfma_f32_32x32x16_bf16 v[48:63], v[184:187], v[168:171], v[48:63]
  ds_read_b64_tr_b16 v[150:151], v9 offset:8704
  ds_read_b64_tr_b16 v[152:153], v9 offset:10240
  ds_read_b64_tr_b16 v[154:155], v9 offset:10752
  s_waitcnt lgkmcnt(7)
  v_mfma_f32_32x32x16_bf16 v[32:47], v[132:135], v[192:195], v[32:47]
  ds_read_b128 v[208:211], v6 offset:24576
  ds_read_b64_tr_b16 v[212:213], v9 offset:12288
  ds_read_b64_tr_b16 v[214:215], v9 offset:12800
  ds_read_b64_tr_b16 v[164:165], v9 offset:14336
  v_mfma_f32_32x32x16_bf16 v[48:63], v[192:195], v[136:139], v[48:63]
  ds_read_b64_tr_b16 v[166:167], v9 offset:14848
  ds_read_b64_tr_b16 v[168:169], v9 offset:16384
  ds_read_b64_tr_b16 v[170:171], v9 offset:16896
  s_waitcnt lgkmcnt(7)
  v_mfma_f32_32x32x16_bf16 v[32:47], v[148:151], v[200:203], v[32:47]
  ds_read_b128 v[216:219], v7 offset:24576
  ds_read_b64_tr_b16 v[220:221], v9 offset:18432
  ds_read_b64_tr_b16 v[222:223], v9 offset:18944
  ds_read_b64_tr_b16 v[132:133], v9 offset:20480
  v_mfma_f32_32x32x16_bf16 v[48:63], v[200:203], v[152:155], v[48:63]
  ds_read_b64_tr_b16 v[134:135], v9 offset:20992
  ds_read_b64_tr_b16 v[136:137], v9 offset:22528
  ds_read_b64_tr_b16 v[138:139], v9 offset:23040
  s_waitcnt vmcnt(0) lgkmcnt(7)
  s_barrier
  v_mfma_f32_32x32x16_bf16 v[32:47], v[164:167], v[208:211], v[32:47]
  ds_read_b128 v[224:227], v4 offset:28672
  ds_read_b64_tr_b16 v[228:229], v9 offset:24576
  ds_read_b64_tr_b16 v[230:231], v9 offset:25088
  ds_read_b64_tr_b16 v[148:149], v9 offset:26624
  v_mfma_f32_32x32x16_bf16 v[48:63], v[208:211], v[168:171], v[48:63]
  ds_read_b64_tr_b16 v[150:151], v9 offset:27136
  ds_read_b64_tr_b16 v[152:153], v9 offset:28672
  ds_read_b64_tr_b16 v[154:155], v9 offset:29184
  s_waitcnt lgkmcnt(7)
  v_mfma_f32_32x32x16_bf16 v[32:47], v[132:135], v[216:219], v[32:47]
  ds_read_b128 v[232:235], v5 offset:28672
  ds_read_b64_tr_b16 v[236:237], v9 offset:30720
  ds_read_b64_tr_b16 v[238:239], v9 offset:31232
  ds_read_b64_tr_b16 v[164:165], v9 offset:32768
  v_mfma_f32_32x32x16_bf16 v[48:63], v[216:219], v[136:139], v[48:63]
  ds_read_b64_tr_b16 v[166:167], v9 offset:33280
  ds_read_b64_tr_b16 v[168:169], v9 offset:34816
  ds_read_b64_tr_b16 v[170:171], v9 offset:35328
  s_waitcnt lgkmcnt(7)
  v_mfma_f32_32x32x16_bf16 v[32:47], v[148:151], v[224:227], v[32:47]
  ds_read_b128 v[240:243], v6 offset:28672
  ds_read_b64_tr_b16 v[244:245], v9 offset:36864
  ds_read_b64_tr_b16 v[246:247], v9 offset:37376
  ds_read_b64_tr_b16 v[132:133], v9 offset:38912
  v_mfma_f32_32x32x16_bf16 v[48:63], v[224:227], v[152:155], v[48:63]
  ds_read_b64_tr_b16 v[134:135], v9 offset:39424
  ds_read_b64_tr_b16 v[136:137], v9 offset:40960
  ds_read_b64_tr_b16 v[138:139], v9 offset:41472
  s_waitcnt lgkmcnt(7)
  v_mfma_f32_32x32x16_bf16 v[32:47], v[164:167], v[232:235], v[32:47]
  ds_read_b128 v[248:251], v7 offset:28672
  ds_read_b64_tr_b16 v[252:253], v9 offset:43008
  ds_read_b64_tr_b16 v[254:255], v9 offset:43520
  ds_read_b64_tr_b16 v[148:149], v9 offset:45056
  v_mfma_f32_32x32x16_bf16 v[48:63], v[232:235], v[168:171], v[48:63]
  ds_read_b64_tr_b16 v[150:151], v9 offset:45568
  ds_read_b64_tr_b16 v[152:153], v9 offset:47104
  ds_read_b64_tr_b16 v[154:155], v9 offset:47616
  s_waitcnt lgkmcnt(7)
  v_mfma_f32_32x32x16_bf16 v[32:47], v[132:135], v[240:243], v[32:47]
  v_mfma_f32_32x32x16_bf16 v[48:63], v[240:243], v[136:139], v[48:63]
  s_waitcnt lgkmcnt(0)
  s_barrier
  v_mfma_f32_32x32x16_bf16 v[32:47], v[148:151], v[248:251], v[32:47]
  v_mfma_f32_32x32x16_bf16 v[48:63], v[248:251], v[152:155], v[48:63]
  v_mfma_f32_32x32x16_bf16 v[16:31], v[180:183], v[176:179], v[16:31]
  v_subrev_u32 v4, s20, v4
  v_subrev_u32 v5, s20, v5
  v_subrev_u32 v6, s20, v6
  v_mfma_f32_32x32x16_bf16 v[16:31], v[188:191], v[184:187], v[16:31]
  v_subrev_u32 v7, s20, v7
  s_mul_i32 s71, s21, 0x38000
  s_nop 3
  v_mfma_f32_32x32x16_bf16 v[16:31], v[196:199], v[192:195], v[16:31]
  v_cvt_pk_bf16_f32 v72, v32, v33
  v_cvt_pk_bf16_f32 v73, v34, v35
  v_cvt_pk_bf16_f32 v74, v36, v37
  v_mfma_f32_32x32x16_bf16 v[16:31], v[204:207], v[200:203], v[16:31]
  v_cvt_pk_bf16_f32 v75, v38, v39
  buffer_store_dwordx4 v[72:75], v10, s[52:55], s6 offen offset:0 sc1
  v_cvt_pk_bf16_f32 v76, v40, v41
  v_mfma_f32_32x32x16_bf16 v[16:31], v[212:215], v[208:211], v[16:31]
  v_cvt_pk_bf16_f32 v77, v42, v43
  v_cvt_pk_bf16_f32 v78, v44, v45
  v_cvt_pk_bf16_f32 v79, v46, v47
  v_mfma_f32_32x32x16_bf16 v[16:31], v[220:223], v[216:219], v[16:31]
  buffer_store_dwordx4 v[76:79], v10, s[52:55], s7 offen offset:0 sc1
  v_cvt_pk_bf16_f32 v80, v48, v49
  v_cvt_pk_bf16_f32 v81, v50, v51
  v_mfma_f32_32x32x16_bf16 v[16:31], v[228:231], v[224:227], v[16:31]
  v_cvt_pk_bf16_f32 v82, v52, v53
  v_cvt_pk_bf16_f32 v83, v54, v55
  buffer_store_dwordx4 v[80:83], v11, s[52:55], s6 offen offset:1024 sc1
  v_mfma_f32_32x32x16_bf16 v[16:31], v[236:239], v[232:235], v[16:31]
  v_cvt_pk_bf16_f32 v84, v56, v57
  v_cvt_pk_bf16_f32 v85, v58, v59
  v_cvt_pk_bf16_f32 v86, v60, v61
  v_mfma_f32_32x32x16_bf16 v[16:31], v[244:247], v[240:243], v[16:31]
  v_cvt_pk_bf16_f32 v87, v62, v63
  buffer_store_dwordx4 v[84:87], v11, s[52:55], s6 offen offset:1536 sc1
  v_mfma_f32_32x32x16_bf16 v[16:31], v[252:255], v[248:251], v[16:31]
  s_nop 11
  v_mul_f32 v16, s73, v16
  v_mul_f32 v17, s73, v17
  v_cvt_pk_bf16_f32 v64, v16, v17
  v_mul_f32 v18, s73, v18
  v_mul_f32 v19, s73, v19
  v_cvt_pk_bf16_f32 v65, v18, v19
  v_mul_f32 v20, s73, v20
  v_mul_f32 v21, s73, v21
  v_cvt_pk_bf16_f32 v66, v20, v21
  v_mul_f32 v22, s73, v22
  v_mul_f32 v23, s73, v23
  v_cvt_pk_bf16_f32 v67, v22, v23
  buffer_store_dwordx4 v[64:67], v10, s[52:55], s4 offen sc1
  v_mul_f32 v24, s73, v24
  v_mul_f32 v25, s73, v25
  v_cvt_pk_bf16_f32 v68, v24, v25
  v_mul_f32 v26, s73, v26
  v_mul_f32 v27, s73, v27
  v_cvt_pk_bf16_f32 v69, v26, v27
  v_mul_f32 v28, s73, v28
  v_mul_f32 v29, s73, v29
  v_cvt_pk_bf16_f32 v70, v28, v29
  v_mul_f32 v30, s73, v30
  v_mul_f32 v31, s73, v31
  v_cvt_pk_bf16_f32 v71, v30, v31
  buffer_store_dwordx4 v[68:71], v10, s[52:55], s5 offen sc1
  ds_read_b64 v[96:97], v126 offset:0
  ds_read_b64 v[98:99], v126 offset:16
  ds_read_b64 v[100:101], v126 offset:32
  ds_read_b64 v[102:103], v126 offset:48
  s_waitcnt vmcnt(0) lgkmcnt(0)
  s_barrier
  s_cmp_lg_u32 s60, 0
  s_cbranch_scc1 L_f1_a
  s_mov_b64 exec, 1
  buffer_store_dword v110, v111, s[52:55], s8 offen sc1
  s_mov_b64 exec, -1
L_f1_a:
  s_mov_b32 s4, 0x0
  s_mov_b32 s5, 0xe000
  s_mov_b32 s6, 0x1c000
  s_mov_b32 s7, 0x2a000
  s_barrier
  s_cmp_lg_u32 s63, 7
  s_cbranch_scc1 L_gu_go
  s_branch L_down
L_gu_go:
  s_add_u32 m0, s14, 0x0
  s_add_u32 s72, s71, s4
  buffer_load_dwordx4 v116, s[32:35], s72 offen lds
  buffer_load_dwordx4 v117, s[32:35], s72 offen offset:1024 lds
  s_add_u32 m0, s14, 0x800
  s_nop 0
  buffer_load_dwordx4 v118, s[36:39], s72 offen lds
  buffer_load_dwordx4 v119, s[36:39], s72 offen offset:1024 lds
  s_waitcnt vmcnt(4)
  s_add_u32 m0, s14, 0x1000
  s_add_u32 s72, s71, s5
  buffer_load_dwordx4 v116, s[32:35], s72 offen lds
  buffer_load_dwordx4 v117, s[32:35], s72 offen offset:1024 lds
  s_add_u32 m0, s14, 0x1800
  s_nop 0
  buffer_load_dwordx4 v118, s[36:39], s72 offen lds
  buffer_load_dwordx4 v119, s[36:39], s72 offen offset:1024 lds
  s_waitcnt vmcnt(4)
  s_add_u32 m0, s14, 0x2000
  s_add_u32 s72, s71, s6
  buffer_load_dwordx4 v116, s[32:35], s72 offen lds
  buffer_load_dwordx4 v117, s[32:35], s72 offen offset:1024 lds
  s_add_u32 m0, s14, 0x2800
  s_nop 0
  buffer_load_dwordx4 v118, s[36:39], s72 offen lds
  buffer_load_dwordx4 v119, s[36:39], s72 offen offset:1024 lds
  s_waitcnt vmcnt(4)
  s_add_u32 m0, s14, 0x3000
  s_add_u32 s72, s71, s7
  buffer_load_dwordx4 v116, s[32:35], s72 offen lds
  buffer_load_dwordx4 v117, s[32:35], s72 offen offset:1024 lds
  s_add_u32 m0, s14, 0x3800
  s_nop 0
  buffer_load_dwordx4 v118, s[36:39], s72 offen lds
  buffer_load_dwordx4 v119, s[36:39], s72 offen offset:1024 lds
  s_waitcnt vmcnt(12)
  ds_read_b128 v[48:51], v4 offset:0
  ds_read_b64_tr_b16 v[16:17], v112 offset:0
  ds_read_b64_tr_b16 v[18:19], v112 offset:512
  ds_read_b128 v[52:55], v4 offset:32768
  ds_read_b64_tr_b16 v[20:21], v113 offset:0
  ds_read_b64_tr_b16 v[22:23], v113 offset:512
  ds_read_b64_tr_b16 v[24:25], v114 offset:0
  ds_read_b64_tr_b16 v[26:27], v114 offset:512
  ds_read_b64_tr_b16 v[28:29], v115 offset:0
  ds_read_b64_tr_b16 v[30:31], v115 offset:512
  s_mov_b32 s67, 1
  s_setprio 0
  s_waitcnt lgkmcnt(0)
  v_mfma_f32_32x32x16_bf16 v[128:143], v[16:19], v[48:51], 0
  s_xor_b32 s71, s67, s21
  s_mul_i32 s71, s71, 0x38000
  s_waitcnt vmcnt(6)
  s_add_u32 m0, s14, 0x0
  s_add_u32 s72, s71, s4
  buffer_load_dwordx4 v116, s[32:35], s72 offen lds
  buffer_load_dwordx4 v117, s[32:35], s72 offen offset:1024 lds
  ds_read_b128 v[56:59], v5 offset:0
  ds_read_b64_tr_b16 v[32:33], v112 offset:4096
  ds_read_b64_tr_b16 v[34:35], v112 offset:4608
  v_mfma_f32_32x32x16_bf16 v[144:159], v[20:23], v[48:51], 0
  ds_read_b128 v[60:63], v5 offset:32768
  ds_read_b64_tr_b16 v[36:37], v113 offset:4096
  ds_read_b64_tr_b16 v[38:39], v113 offset:4608
  v_mfma_f32_32x32x16_bf16 v[160:175], v[24:27], v[48:51], 0
  ds_read_b64_tr_b16 v[40:41], v114 offset:4096
  ds_read_b64_tr_b16 v[42:43], v114 offset:4608
  v_mfma_f32_32x32x16_bf16 v[176:191], v[28:31], v[48:51], 0
  ds_read_b64_tr_b16 v[44:45], v115 offset:4096
  ds_read_b64_tr_b16 v[46:47], v115 offset:4608
  v_mfma_f32_32x32x16_bf16 v[240:255], v[28:31], v[52:55], 0
  s_waitcnt vmcnt(6)
  s_add_u32 m0, s14, 0x800
  s_nop 0
  buffer_load_dwordx4 v118, s[36:39], s72 offen lds
  buffer_load_dwordx4 v119, s[36:39], s72 offen offset:1024 lds
  v_mfma_f32_32x32x16_bf16 v[224:239], v[24:27], v[52:55], 0
  v_mfma_f32_32x32x16_bf16 v[208:223], v[20:23], v[52:55], 0
  v_mfma_f32_32x32x16_bf16 v[192:207], v[16:19], v[52:55], 0
  s_branch L_gu_1
L_gu_0:
  s_waitcnt lgkmcnt(0)
  v_mfma_f32_32x32x16_bf16 v[128:143], v[16:19], v[48:51], v[128:143]
  s_xor_b32 s71, s67, s21
  s_mul_i32 s71, s71, 0x38000
  s_waitcnt vmcnt(6)
  s_add_u32 m0, s14, 0x0
  s_add_u32 s72, s71, s4
  buffer_load_dwordx4 v116, s[32:35], s72 offen lds
  buffer_load_dwordx4 v117, s[32:35], s72 offen offset:1024 lds
  ds_read_b128 v[56:59], v5 offset:0
  ds_read_b64_tr_b16 v[32:33], v112 offset:4096
  ds_read_b64_tr_b16 v[34:35], v112 offset:4608
  v_mfma_f32_32x32x16_bf16 v[144:159], v[20:23], v[48:51], v[144:159]
  ds_read_b128 v[60:63], v5 offset:32768
  ds_read_b64_tr_b16 v[36:37], v113 offset:4096
  ds_read_b64_tr_b16 v[38:39], v113 offset:4608
  v_mfma_f32_32x32x16_bf16 v[160:175], v[24:27], v[48:51], v[160:175]
  ds_read_b64_tr_b16 v[40:41], v114 offset:4096
  ds_read_b64_tr_b16 v[42:43], v114 offset:4608
  v_mfma_f32_32x32x16_bf16 v[176:191], v[28:31], v[48:51], v[176:191]
  ds_read_b64_tr_b16 v[44:45], v115 offset:4096
  ds_read_b64_tr_b16 v[46:47], v115 offset:4608
  v_mfma_f32_32x32x16_bf16 v[240:255], v[28:31], v[52:55], v[240:255]
  s_waitcnt vmcnt(6)
  s_add_u32 m0, s14, 0x800
  s_nop 0
  buffer_load_dwordx4 v118, s[36:39], s72 offen lds
  buffer_load_dwordx4 v119, s[36:39], s72 offen offset:1024 lds
  v_mfma_f32_32x32x16_bf16 v[224:239], v[24:27], v[52:55], v[224:239]
  v_mfma_f32_32x32x16_bf16 v[208:223], v[20:23], v[52:55], v[208:223]
  v_mfma_f32_32x32x16_bf16 v[192:207], v[16:19], v[52:55], v[192:207]
L_gu_1:
  s_waitcnt lgkmcnt(0)
  v_mfma_f32_32x32x16_bf16 v[128:143], v[32:35], v[56:59], v[128:143]
  s_waitcnt vmcnt(6)
  s_add_u32 m0, s14, 0x1000
  s_add_u32 s72, s71, s5
  buffer_load_dwordx4 v116, s[32:35], s72 offen lds
  buffer_load_dwordx4 v117, s[32:35], s72 offen offset:1024 lds
  ds_read_b128 v[48:51], v6 offset:0
  ds_read_b64_tr_b16 v[16:17], v112 offset:8192
  ds_read_b64_tr_b16 v[18:19], v112 offset:8704
  v_mfma_f32_32x32x16_bf16 v[144:159], v[36:39], v[56:59], v[144:159]
  ds_read_b128 v[52:55], v6 offset:32768
  ds_read_b64_tr_b16 v[20:21], v113 offset:8192
  ds_read_b64_tr_b16 v[22:23], v113 offset:8704
  v_mfma_f32_32x32x16_bf16 v[160:175], v[40:43], v[56:59], v[160:175]
  ds_read_b64_tr_b16 v[24:25], v114 offset:8192
  ds_read_b64_tr_b16 v[26:27], v114 offset:8704
  v_mfma_f32_32x32x16_bf16 v[176:191], v[44:47], v[56:59], v[176:191]
  ds_read_b64_tr_b16 v[28:29], v115 offset:8192
  ds_read_b64_tr_b16 v[30:31], v115 offset:8704
  v_mfma_f32_32x32x16_bf16 v[240:255], v[44:47], v[60:63], v[240:255]
  s_waitcnt vmcnt(6)
  s_add_u32 m0, s14, 0x1800
  s_nop 0
  buffer_load_dwordx4 v118, s[36:39], s72 offen lds
  buffer_load_dwordx4 v119, s[36:39], s72 offen offset:1024 lds
  v_mfma_f32_32x32x16_bf16 v[224:239], v[40:43], v[60:63], v[224:239]
  v_mfma_f32_32x32x16_bf16 v[208:223], v[36:39], v[60:63], v[208:223]
  v_mfma_f32_32x32x16_bf16 v[192:207], v[32:35], v[60:63], v[192:207]
  s_cmp_eq_u32 s67, 8
  s_cbranch_scc1 L_gu_last
  s_waitcnt lgkmcnt(0)
  v_mfma_f32_32x32x16_bf16 v[128:143], v[16:19], v[48:51], v[128:143]
  s_waitcnt vmcnt(6)
  s_add_u32 m0, s14, 0x2000
  s_add_u32 s72, s71, s6
  buffer_load_dwordx4 v116, s[32:35], s72 offen lds
  buffer_load_dwordx4 v117, s[32:35], s72 offen offset:1024 lds
  ds_read_b128 v[56:59], v7 offset:0
  ds_read_b64_tr_b16 v[32:33], v112 offset:12288
  ds_read_b64_tr_b16 v[34:35], v112 offset:12800
  v_mfma_f32_32x32x16_bf16 v[144:159], v[20:23], v[48:51], v[144:159]
  ds_read_b128 v[60:63], v7 offset:32768
  ds_read_b64_tr_b16 v[36:37], v113 offset:12288
  ds_read_b64_tr_b16 v[38:39], v113 offset:12800
  v_mfma_f32_32x32x16_bf16 v[160:175], v[24:27], v[48:51], v[160:175]
  ds_read_b64_tr_b16 v[40:41], v114 offset:12288
  ds_read_b64_tr_b16 v[42:43], v114 offset:12800
  v_mfma_f32_32x32x16_bf16 v[176:191], v[28:31], v[48:51], v[176:191]
  ds_read_b64_tr_b16 v[44:45], v115 offset:12288
  ds_read_b64_tr_b16 v[46:47], v115 offset:12800
  v_mfma_f32_32x32x16_bf16 v[240:255], v[28:31], v[52:55], v[240:255]
  s_waitcnt vmcnt(6)
  s_add_u32 m0, s14, 0x2800
  s_nop 0
  buffer_load_dwordx4 v118, s[36:39], s72 offen lds
  buffer_load_dwordx4 v119, s[36:39], s72 offen offset:1024 lds
  v_mfma_f32_32x32x16_bf16 v[224:239], v[24:27], v[52:55], v[224:239]
  v_mfma_f32_32x32x16_bf16 v[208:223], v[20:23], v[52:55], v[208:223]
  v_mfma_f32_32x32x16_bf16 v[192:207], v[16:19], v[52:55], v[192:207]
  s_waitcnt lgkmcnt(0)
  v_mfma_f32_32x32x16_bf16 v[128:143], v[32:35], v[56:59], v[128:143]
  s_setprio 3
  v_add_u32 v4, 0x1000, v4
  v_add_u32 v5, 0x1000, v5
  v_add_u32 v6, 0x1000, v6
  v_add_u32 v7, 0x1000, v7
  s_setprio 0
  s_waitcnt vmcnt(6)
  s_add_u32 m0, s14, 0x3000
  s_add_u32 s72, s71, s7
  buffer_load_dwordx4 v116, s[32:35], s72 offen lds
  buffer_load_dwordx4 v117, s[32:35], s72 offen offset:1024 lds
  ds_read_b128 v[48:51], v4 offset:0
  ds_read_b64_tr_b16 v[16:17], v112 offset:0
  ds_read_b64_tr_b16 v[18:19], v112 offset:512
  v_mfma_f32_32x32x16_bf16 v[144:159], v[36:39], v[56:59], v[144:159]
  ds_read_b128 v[52:55], v4 offset:32768
  ds_read_b64_tr_b16 v[20:21], v113 offset:0
  ds_read_b64_tr_b16 v[22:23], v113 offset:512
  v_mfma_f32_32x32x16_bf16 v[160:175], v[40:43], v[56:59], v[160:175]
  ds_read_b64_tr_b16 v[24:25], v114 offset:0
  ds_read_b64_tr_b16 v[26:27], v114 offset:512
  v_mfma_f32_32x32x16_bf16 v[176:191], v[44:47], v[56:59], v[176:191]
  ds_read_b64_tr_b16 v[28:29], v115 offset:0
  ds_read_b64_tr_b16 v[30:31], v115 offset:512
  v_mfma_f32_32x32x16_bf16 v[240:255], v[44:47], v[60:63], v[240:255]
  s_waitcnt vmcnt(6)
  s_add_u32 m0, s14, 0x3800
  s_nop 0
  buffer_load_dwordx4 v118, s[36:39], s72 offen lds
  buffer_load_dwordx4 v119, s[36:39], s72 offen offset:1024 lds
  v_mfma_f32_32x32x16_bf16 v[224:239], v[40:43], v[60:63], v[224:239]
  v_mfma_f32_32x32x16_bf16 v[208:223], v[36:39], v[60:63], v[208:223]
  v_mfma_f32_32x32x16_bf16 v[192:207], v[32:35], v[60:63], v[192:207]
  s_add_u32 s67, s67, 1
  s_branch L_gu_0
L_gu_last:
  s_waitcnt vmcnt(0) lgkmcnt(0)
  v_mfma_f32_32x32x16_bf16 v[128:143], v[16:19], v[48:51], v[128:143]
  ds_read_b128 v[56:59], v7 offset:0
  ds_read_b64_tr_b16 v[32:33], v112 offset:12288
  ds_read_b64_tr_b16 v[34:35], v112 offset:12800
  ds_read_b128 v[60:63], v7 offset:32768
  ds_read_b64_tr_b16 v[36:37], v113 offset:12288
  ds_read_b64_tr_b16 v[38:39], v113 offset:12800
  v_mfma_f32_32x32x16_bf16 v[192:207], v[16:19], v[52:55], v[192:207]
  ds_read_b64_tr_b16 v[40:41], v114 offset:12288
  ds_read_b64_tr_b16 v[42:43], v114 offset:12800
  ds_read_b64_tr_b16 v[44:45], v115 offset:12288
  ds_read_b64_tr_b16 v[46:47], v115 offset:12800
  v_mfma_f32_32x32x16_bf16 v[208:223], v[20:23], v[52:55], v[208:223]
  v_mfma_f32_32x32x16_bf16 v[144:159], v[20:23], v[48:51], v[144:159]
  s_waitcnt lgkmcnt(0)
  v_mfma_f32_32x32x16_bf16 v[128:143], v[32:35], v[56:59], v[128:143]
  v_mfma_f32_32x32x16_bf16 v[192:207], v[32:35], v[60:63], v[192:207]
  s_setprio 3
  s_lshl_b32 s68, s60, 2
  s_add_u32 s68, s68, 0x10000
  v_mov_b32 v108, s68
  v_mov_b32 v109, 1
  ds_write_b32 v108, v109 offset:16
  s_add_u32 m0, s14, 0x0
  s_nop 0
  buffer_load_dwordx4 v124, s[40:43], s19 offen lds
  buffer_load_dwordx4 v125, s[40:43], s19 offen offset:1024 lds
  s_add_u32 s19, s19, 0x4000
  s_cmp_eq_u32 s19, s59
  s_cselect_b32 s19, s57, s19
  v_mfma_f32_32x32x16_bf16 v[144:159], v[36:39], v[56:59], v[144:159]
  v_mfma_f32_32x32x16_bf16 v[208:223], v[36:39], v[60:63], v[208:223]
  v_mfma_f32_32x32x16_bf16 v[160:175], v[24:27], v[48:51], v[160:175]
  v_max_f32 v128, 0, v128
  v_max_f32 v129, 0, v129
  v_max_f32 v130, 0, v130
  v_max_f32 v131, 0, v131
  v_max_f32 v132, 0, v132
  v_max_f32 v133, 0, v133
  v_max_f32 v134, 0, v134
  v_mfma_f32_32x32x16_bf16 v[224:239], v[24:27], v[52:55], v[224:239]
  v_max_f32 v135, 0, v135
  v_pk_mul_f32 v[128:129], v[128:129], v[136:137]
  v_pk_mul_f32 v[130:131], v[130:131], v[138:139]
  v_pk_mul_f32 v[132:133], v[132:133], v[140:141]
  v_pk_mul_f32 v[134:135], v[134:135], v[142:143]
  v_cvt_pk_bf16_f32 v64, v128, v129
  v_cvt_pk_bf16_f32 v65, v130, v131
  v_mfma_f32_32x32x16_bf16 v[160:175], v[40:43], v[56:59], v[160:175]
  v_cvt_pk_bf16_f32 v66, v132, v133
  v_cvt_pk_bf16_f32 v67, v134, v135
  buffer_store_dwordx4 v[64:67], v10, s[52:55], s12 offen offset:0 sc1
  v_max_f32 v192, 0, v192
  v_max_f32 v193, 0, v193
  v_max_f32 v194, 0, v194
  v_max_f32 v195, 0, v195
  v_mfma_f32_32x32x16_bf16 v[224:239], v[40:43], v[60:63], v[224:239]
  v_max_f32 v196, 0, v196
  v_max_f32 v197, 0, v197
  v_max_f32 v198, 0, v198
  v_max_f32 v199, 0, v199
  v_pk_mul_f32 v[192:193], v[192:193], v[200:201]
  v_pk_mul_f32 v[194:195], v[194:195], v[202:203]
  v_pk_mul_f32 v[196:197], v[196:197], v[204:205]
  v_mfma_f32_32x32x16_bf16 v[240:255], v[28:31], v[52:55], v[240:255]
  v_pk_mul_f32 v[198:199], v[198:199], v[206:207]
  v_cvt_pk_bf16_f32 v68, v192, v193
  v_cvt_pk_bf16_f32 v69, v194, v195
  v_cvt_pk_bf16_f32 v70, v196, v197
  v_cvt_pk_bf16_f32 v71, v198, v199
  buffer_store_dwordx4 v[68:71], v10, s[52:55], s13 offen offset:0 sc1
  v_max_f32 v144, 0, v144
  v_mfma_f32_32x32x16_bf16 v[176:191], v[28:31], v[48:51], v[176:191]
  v_max_f32 v145, 0, v145
  v_max_f32 v146, 0, v146
  v_max_f32 v147, 0, v147
  v_max_f32 v148, 0, v148
  v_max_f32 v149, 0, v149
  v_max_f32 v150, 0, v150
  v_max_f32 v151, 0, v151
  v_mfma_f32_32x32x16_bf16 v[176:191], v[44:47], v[56:59], v[176:191]
  v_pk_mul_f32 v[144:145], v[144:145], v[152:153]
  v_pk_mul_f32 v[146:147], v[146:147], v[154:155]
  v_pk_mul_f32 v[148:149], v[148:149], v[156:157]
  v_pk_mul_f32 v[150:151], v[150:151], v[158:159]
  v_cvt_pk_bf16_f32 v72, v144, v145
  v_cvt_pk_bf16_f32 v73, v146, v147
  v_cvt_pk_bf16_f32 v74, v148, v149
  v_mfma_f32_32x32x16_bf16 v[240:255], v[44:47], v[60:63], v[240:255]
  v_cvt_pk_bf16_f32 v75, v150, v151
  buffer_store_dwordx4 v[72:75], v10, s[52:55], s12 offen offset:1024 sc1
  v_max_f32 v208, 0, v208
  v_max_f32 v209, 0, v209
  v_max_f32 v210, 0, v210
  v_max_f32 v211, 0, v211
  v_max_f32 v212, 0, v212
  v_max_f32 v213, 0, v213
  v_max_f32 v214, 0, v214
  v_max_f32 v215, 0, v215
  v_pk_mul_f32 v[208:209], v[208:209], v[216:217]
  v_pk_mul_f32 v[210:211], v[210:211], v[218:219]
  v_pk_mul_f32 v[212:213], v[212:213], v[220:221]
  v_pk_mul_f32 v[214:215], v[214:215], v[222:223]
  v_cvt_pk_bf16_f32 v76, v208, v209
  v_cvt_pk_bf16_f32 v77, v210, v211
  v_cvt_pk_bf16_f32 v78, v212, v213
  v_cvt_pk_bf16_f32 v79, v214, v215
  buffer_store_dwordx4 v[76:79], v10, s[52:55], s13 offen offset:1024 sc1
  v_max_f32 v160, 0, v160
  v_max_f32 v161, 0, v161
  v_max_f32 v162, 0, v162
  v_max_f32 v163, 0, v163
  v_max_f32 v164, 0, v164
  v_max_f32 v165, 0, v165
  v_max_f32 v166, 0, v166
  v_max_f32 v167, 0, v167
  v_pk_mul_f32 v[160:161], v[160:161], v[168:169]
  v_pk_mul_f32 v[162:163], v[162:163], v[170:171]
  v_pk_mul_f32 v[164:165], v[164:165], v[172:173]
  v_pk_mul_f32 v[166:167], v[166:167], v[174:175]
  v_cvt_pk_bf16_f32 v80, v160, v161
  v_cvt_pk_bf16_f32 v81, v162, v163
  v_cvt_pk_bf16_f32 v82, v164, v165
  v_cvt_pk_bf16_f32 v83, v166, v167
  buffer_store_dwordx4 v[80:83], v10, s[52:55], s12 offen offset:2048 sc1
  v_max_f32 v224, 0, v224
  v_max_f32 v225, 0, v225
  v_max_f32 v226, 0, v226
  v_max_f32 v227, 0, v227
  v_max_f32 v228, 0, v228
  v_max_f32 v229, 0, v229
  v_max_f32 v230, 0, v230
  v_max_f32 v231, 0, v231
  v_pk_mul_f32 v[224:225], v[224:225], v[232:233]
  v_pk_mul_f32 v[226:227], v[226:227], v[234:235]
  v_pk_mul_f32 v[228:229], v[228:229], v[236:237]
  v_pk_mul_f32 v[230:231], v[230:231], v[238:239]
  v_cvt_pk_bf16_f32 v84, v224, v225
  v_cvt_pk_bf16_f32 v85, v226, v227
  v_cvt_pk_bf16_f32 v86, v228, v229
  v_cvt_pk_bf16_f32 v87, v230, v231
  buffer_store_dwordx4 v[84:87], v10, s[52:55], s13 offen offset:2048 sc1
  v_max_f32 v176, 0, v176
  v_max_f32 v177, 0, v177
  v_max_f32 v178, 0, v178
  v_max_f32 v179, 0, v179
  v_max_f32 v180, 0, v180
  v_max_f32 v181, 0, v181
  v_max_f32 v182, 0, v182
  v_max_f32 v183, 0, v183
  v_pk_mul_f32 v[176:177], v[176:177], v[184:185]
  v_pk_mul_f32 v[178:179], v[178:179], v[186:187]
  v_pk_mul_f32 v[180:181], v[180:181], v[188:189]
  v_pk_mul_f32 v[182:183], v[182:183], v[190:191]
  v_cvt_pk_bf16_f32 v88, v176, v177
  v_cvt_pk_bf16_f32 v89, v178, v179
  v_cvt_pk_bf16_f32 v90, v180, v181
  v_cvt_pk_bf16_f32 v91, v182, v183
  buffer_store_dwordx4 v[88:91], v10, s[52:55], s12 offen offset:3072 sc1
  v_max_f32 v240, 0, v240
  v_max_f32 v241, 0, v241
  v_max_f32 v242, 0, v242
  v_max_f32 v243, 0, v243
  v_max_f32 v244, 0, v244
  v_max_f32 v245, 0, v245
  v_max_f32 v246, 0, v246
  v_max_f32 v247, 0, v247
  v_pk_mul_f32 v[240:241], v[240:241], v[248:249]
  v_pk_mul_f32 v[242:243], v[242:243], v[250:251]
  v_pk_mul_f32 v[244:245], v[244:245], v[252:253]
  v_pk_mul_f32 v[246:247], v[246:247], v[254:255]
  v_cvt_pk_bf16_f32 v92, v240, v241
  v_cvt_pk_bf16_f32 v93, v242, v243
  v_cvt_pk_bf16_f32 v94, v244, v245
  v_cvt_pk_bf16_f32 v95, v246, v247
  buffer_store_dwordx4 v[92:95], v10, s[52:55], s13 offen offset:3072 sc1
  s_waitcnt vmcnt(0)
  s_mov_b64 exec, 1
  buffer_store_dword v110, v111, s[52:55], s15 offen sc1
  s_mov_b64 exec, -1
  s_branch L_down2
L_down:
  s_setprio 3
  s_lshl_b32 s68, s60, 2
  s_add_u32 s68, s68, 0x10000
  v_mov_b32 v108, s68
  v_mov_b32 v109, 1
  ds_write_b32 v108, v109 offset:16
  s_add_u32 m0, s14, 0x0
  s_nop 0
  buffer_load_dwordx4 v124, s[40:43], s19 offen lds
  buffer_load_dwordx4 v125, s[40:43], s19 offen offset:1024 lds
  s_add_u32 s19, s19, 0x4000
  s_cmp_eq_u32 s19, s59
  s_cselect_b32 s19, s57, s19
L_down2:
  s_waitcnt vmcnt(6)
  s_add_u32 m0, s14, 0x800
  s_nop 0
  buffer_load_dwordx4 v124, s[40:43], s19 offen lds
  buffer_load_dwordx4 v125, s[40:43], s19 offen offset:1024 lds
  s_add_u32 s19, s19, 0x4000
  s_cmp_eq_u32 s19, s59
  s_cselect_b32 s19, s57, s19
  s_waitcnt vmcnt(6)
  s_add_u32 m0, s14, 0x1000
  s_nop 0
  buffer_load_dwordx4 v124, s[40:43], s19 offen lds
  buffer_load_dwordx4 v125, s[40:43], s19 offen offset:1024 lds
  s_add_u32 s19, s19, 0x4000
  s_cmp_eq_u32 s19, s59
  s_cselect_b32 s19, s57, s19
  s_waitcnt vmcnt(6)
  s_add_u32 m0, s14, 0x1800
  s_nop 0
  buffer_load_dwordx4 v124, s[40:43], s19 offen lds
  buffer_load_dwordx4 v125, s[40:43], s19 offen offset:1024 lds
  s_add_u32 s19, s19, 0x4000
  s_cmp_eq_u32 s19, s59
  s_cselect_b32 s19, s57, s19
  s_waitcnt vmcnt(6)
  s_add_u32 m0, s14, 0x2000
  s_nop 0
  buffer_load_dwordx4 v124, s[40:43], s19 offen lds
  buffer_load_dwordx4 v125, s[40:43], s19 offen offset:1024 lds
  s_add_u32 s19, s19, 0x4000
  s_cmp_eq_u32 s19, s59
  s_cselect_b32 s19, s57, s19
  s_waitcnt vmcnt(6)
  s_add_u32 m0, s14, 0x2800
  s_nop 0
  buffer_load_dwordx4 v124, s[40:43], s19 offen lds
  buffer_load_dwordx4 v125, s[40:43], s19 offen offset:1024 lds
  s_add_u32 s19, s19, 0x4000
  s_cmp_eq_u32 s19, s59
  s_cselect_b32 s19, s57, s19
  s_waitcnt vmcnt(6)
  s_add_u32 m0, s14, 0x3000
  s_nop 0
  buffer_load_dwordx4 v124, s[40:43], s19 offen lds
  buffer_load_dwordx4 v125, s[40:43], s19 offen offset:1024 lds
  s_add_u32 s19, s19, 0x4000
  s_cmp_eq_u32 s19, s59
  s_cselect_b32 s19, s57, s19
  s_lshl_b32 s73, s60, 17
  s_mul_i32 s72, s60, 0x1800
  s_add_u32 s72, s72, 0x20100
  s_waitcnt vmcnt(6)
  s_add_u32 m0, s14, 0x3800
  s_nop 0
  buffer_load_dwordx4 v124, s[44:47], s73 offen lds
  buffer_load_dwordx4 v125, s[44:47], s73 offen offset:1024 lds
  s_add_u32 s73, s73, 0x4000
  s_waitcnt vmcnt(6)
  s_add_u32 m0, s72, 0x0
  s_nop 0
  buffer_load_dwordx4 v124, s[44:47], s73 offen lds
  buffer_load_dwordx4 v125, s[44:47], s73 offen offset:1024 lds
  s_add_u32 s73, s73, 0x4000
  s_waitcnt vmcnt(6)
  s_add_u32 m0, s72, 0x800
  s_nop 0
  buffer_load_dwordx4 v124, s[44:47], s73 offen lds
  buffer_load_dwordx4 v125, s[44:47], s73 offen offset:1024 lds
  s_add_u32 s73, s73, 0x4000
  s_waitcnt vmcnt(6)
  s_add_u32 m0, s72, 0x1000
  s_nop 0
  buffer_load_dwordx4 v124, s[44:47], s73 offen lds
  buffer_load_dwordx4 v125, s[44:47], s73 offen offset:1024 lds
  s_add_u32 s73, s73, 0x4000
  s_sub_u32 s68, s72, s14
  v_add_u32 v14, s68, v122
  v_add_u32 v15, s68, v123
  s_lshl_b32 s70, s65, 16
  s_lshl_b32 s69, s60, 13
  s_add_u32 s70, s70, s69
  s_add_u32 s70, s70, 0x700000
  s_add_u32 s69, s70, 0x1000
  s_lshr_b32 s68, s60, 1
  s_lshl_b32 s68, s68, 15
  v_add_u32 v12, s68, v10
  s_xor_b32 s68, s68, 0x8000
  v_add_u32 v13, s68, v10
  v_add_u32 v4, s14, v10
  s_xor_b32 s68, s60, 1
  s_lshl_b32 s68, s68, 14
  s_add_u32 s68, s68, 0x10100
  v_add_u32 v5, s68, v10
  s_xor_b32 s68, s60, 2
  s_lshl_b32 s68, s68, 14
  s_add_u32 s68, s68, 0x10100
  v_add_u32 v6, s68, v10
  s_xor_b32 s68, s60, 3
  s_lshl_b32 s68, s68, 14
  s_add_u32 s68, s68, 0x10100
  v_add_u32 v7, s68, v10
  v_lshlrev_b32 v8, 7, v0
  s_mov_b32 s68, 0xffff0000
  v_lshlrev_b32 v128, 16, v96
  v_and_b32 v129, s68, v96
  v_lshlrev_b32 v130, 16, v97
  v_and_b32 v131, s68, v97
  v_lshlrev_b32 v132, 16, v98
  v_and_b32 v133, s68, v98
  v_lshlrev_b32 v134, 16, v99
  v_and_b32 v135, s68, v99
  v_lshlrev_b32 v136, 16, v100
  v_and_b32 v137, s68, v100
  v_lshlrev_b32 v138, 16, v101
  v_and_b32 v139, s68, v101
  v_lshlrev_b32 v140, 16, v102
  v_and_b32 v141, s68, v102
  v_lshlrev_b32 v142, 16, v103
  v_and_b32 v143, s68, v103
  v_mov_b32 v9, 0x10000
  s_mov_b32 s3, 0
  s_mov_b32 exec_lo, 0x7f
  s_mov_b32 exec_hi, 0
L_poll_h:
  buffer_load_dword v3, v8, s[52:55], s16 offen sc1
  s_add_u32 s3, s3, 1
  s_waitcnt vmcnt(0)
  v_cmp_ne_u32 vcc, s75, v3
  s_cmp_gt_u32 s3, 0x40000
  s_cbranch_vccz L_polld_h
  s_cbranch_scc1 L_polld_h
  s_sleep 4
  s_branch L_poll_h
L_polld_h:
  s_mov_b64 exec, -1
  buffer_load_dwordx4 v[32:35], v120, s[52:55], s18 offen sc1
  buffer_load_dwordx4 v[36:39], v121, s[52:55], s18 offen sc1
  s_add_u32 s18, s18, 0x400
  s_cmp_eq_u32 s18, s58
  s_cselect_b32 s18, s56, s18
  buffer_load_dwordx4 v[40:43], v120, s[52:55], s18 offen sc1
  buffer_load_dwordx4 v[44:47], v121, s[52:55], s18 offen sc1
  s_add_u32 s18, s18, 0x400
  s_cmp_eq_u32 s18, s58
  s_cselect_b32 s18, s56, s18
  buffer_load_dwordx4 v[48:51], v120, s[52:55], s18 offen sc1
  buffer_load_dwordx4 v[52:55], v121, s[52:55], s18 offen sc1
  s_add_u32 s18, s18, 0x400
  s_cmp_eq_u32 s18, s58
  s_cselect_b32 s18, s56, s18
  buffer_load_dwordx4 v[56:59], v120, s[52:55], s18 offen sc1
  buffer_load_dwordx4 v[60:63], v121, s[52:55], s18 offen sc1
  s_add_u32 s18, s18, 0x400
  s_cmp_eq_u32 s18, s58
  s_cselect_b32 s18, s56, s18
  s_waitcnt vmcnt(6)
  buffer_load_dwordx4 v[64:67], v120, s[52:55], s18 offen sc1
  buffer_load_dwordx4 v[68:71], v121, s[52:55], s18 offen sc1
  s_add_u32 s18, s18, 0x400
  s_cmp_eq_u32 s18, s58
  s_cselect_b32 s18, s56, s18
  s_waitcnt vmcnt(6)
  buffer_load_dwordx4 v[72:75], v120, s[52:55], s18 offen sc1
  buffer_load_dwordx4 v[76:79], v121, s[52:55], s18 offen sc1
  s_add_u32 s18, s18, 0x400
  s_cmp_eq_u32 s18, s58
  s_cselect_b32 s18, s56, s18
  s_waitcnt vmcnt(6)
  buffer_load_dwordx4 v[80:83], v120, s[52:55], s18 offen sc1
  buffer_load_dwordx4 v[84:87], v121, s[52:55], s18 offen sc1
  s_add_u32 s18, s18, 0x400
  s_cmp_eq_u32 s18, s58
  s_cselect_b32 s18, s56, s18
  ds_read_b64_tr_b16 v[16:17], v122 offset:0
  ds_read_b64_tr_b16 v[18:19], v122 offset:1024
  ds_read_b64_tr_b16 v[20:21], v123 offset:0
  ds_read_b64_tr_b16 v[22:23], v123 offset:1024
  s_mov_b32 s67, 6
  s_setprio 0
  s_waitcnt vmcnt(12) lgkmcnt(0)
  v_mfma_f32_32x32x16_bf16 v[160:175], v[16:19], v[36:39], 0
  ds_read_b64_tr_b16 v[24:25], v122 offset:2048
  ds_read_b64_tr_b16 v[26:27], v122 offset:3072
  ds_read_b64_tr_b16 v[28:29], v123 offset:2048
  ds_read_b64_tr_b16 v[30:31], v123 offset:3072
  v_mfma_f32_32x32x16_bf16 v[176:191], v[20:23], v[36:39], 0
  s_waitcnt vmcnt(4)
  s_add_u32 m0, s14, 0x0
  s_nop 0
  buffer_load_dwordx4 v124, s[40:43], s19 offen lds
  buffer_load_dwordx4 v125, s[40:43], s19 offen offset:1024 lds
  s_add_u32 s19, s19, 0x4000
  s_cmp_eq_u32 s19, s59
  s_cselect_b32 s19, s57, s19
  v_mfma_f32_32x32x16_bf16 v[144:159], v[20:23], v[32:35], 0
  v_mfma_f32_32x32x16_bf16 v[128:143], v[16:19], v[32:35], v[128:143]
  s_waitcnt vmcnt(4)
  buffer_load_dwordx4 v[32:35], v120, s[52:55], s18 offen sc1
  buffer_load_dwordx4 v[36:39], v121, s[52:55], s18 offen sc1
  s_add_u32 s18, s18, 0x400
  s_cmp_eq_u32 s18, s58
  s_cselect_b32 s18, s56, s18
  s_waitcnt vmcnt(14) lgkmcnt(0)
  v_mfma_f32_32x32x16_bf16 v[160:175], v[24:27], v[44:47], v[160:175]
  ds_read_b64_tr_b16 v[16:17], v122 offset:4096
  ds_read_b64_tr_b16 v[18:19], v122 offset:5120
  ds_read_b64_tr_b16 v[20:21], v123 offset:4096
  ds_read_b64_tr_b16 v[22:23], v123 offset:5120
  v_mfma_f32_32x32x16_bf16 v[176:191], v[28:31], v[44:47], v[176:191]
  s_waitcnt vmcnt(4)
  s_add_u32 m0, s14, 0x800
  s_nop 0
  buffer_load_dwordx4 v124, s[40:43], s19 offen lds
  buffer_load_dwordx4 v125, s[40:43], s19 offen offset:1024 lds
  s_add_u32 s19, s19, 0x4000
  s_cmp_eq_u32 s19, s59
  s_cselect_b32 s19, s57, s19
  v_mfma_f32_32x32x16_bf16 v[144:159], v[28:31], v[40:43], v[144:159]
  v_mfma_f32_32x32x16_bf16 v[128:143], v[24:27], v[40:43], v[128:143]
  s_waitcnt vmcnt(4)
  buffer_load_dwordx4 v[40:43], v120, s[52:55], s18 offen sc1
  buffer_load_dwordx4 v[44:47], v121, s[52:55], s18 offen sc1
  s_add_u32 s18, s18, 0x400
  s_cmp_eq_u32 s18, s58
  s_cselect_b32 s18, s56, s18
  s_waitcnt vmcnt(16) lgkmcnt(0)
  v_mfma_f32_32x32x16_bf16 v[160:175], v[16:19], v[52:55], v[160:175]
  ds_read_b64_tr_b16 v[24:25], v122 offset:6144
  ds_read_b64_tr_b16 v[26:27], v122 offset:7168
  ds_read_b64_tr_b16 v[28:29], v123 offset:6144
  ds_read_b64_tr_b16 v[30:31], v123 offset:7168
  v_mfma_f32_32x32x16_bf16 v[176:191], v[20:23], v[52:55], v[176:191]
  s_waitcnt vmcnt(4)
  s_add_u32 m0, s14, 0x1000
  s_nop 0
  buffer_load_dwordx4 v124, s[40:43], s19 offen lds
  buffer_load_dwordx4 v125, s[40:43], s19 offen offset:1024 lds
  s_add_u32 s19, s19, 0x4000
  s_cmp_eq_u32 s19, s59
  s_cselect_b32 s19, s57, s19
  v_mfma_f32_32x32x16_bf16 v[144:159], v[20:23], v[48:51], v[144:159]
  v_mfma_f32_32x32x16_bf16 v[128:143], v[16:19], v[48:51], v[128:143]
  s_waitcnt vmcnt(4)
  buffer_load_dwordx4 v[48:51], v120, s[52:55], s18 offen sc1
  buffer_load_dwordx4 v[52:55], v121, s[52:55], s18 offen sc1
  s_add_u32 s18, s18, 0x400
  s_cmp_eq_u32 s18, s58
  s_cselect_b32 s18, s56, s18
  s_waitcnt vmcnt(18) lgkmcnt(0)
  v_mfma_f32_32x32x16_bf16 v[160:175], v[24:27], v[60:63], v[160:175]
  ds_read_b64_tr_b16 v[16:17], v122 offset:8192
  ds_read_b64_tr_b16 v[18:19], v122 offset:9216
  ds_read_b64_tr_b16 v[20:21], v123 offset:8192
  ds_read_b64_tr_b16 v[22:23], v123 offset:9216
  v_mfma_f32_32x32x16_bf16 v[176:191], v[28:31], v[60:63], v[176:191]
  s_waitcnt vmcnt(4)
  s_add_u32 m0, s14, 0x1800
  s_nop 0
  buffer_load_dwordx4 v124, s[40:43], s19 offen lds
  buffer_load_dwordx4 v125, s[40:43], s19 offen offset:1024 lds
  s_add_u32 s19, s19, 0x4000
  s_cmp_eq_u32 s19, s59
  s_cselect_b32 s19, s57, s19
  v_mfma_f32_32x32x16_bf16 v[144:159], v[28:31], v[56:59], v[144:159]
  v_mfma_f32_32x32x16_bf16 v[128:143], v[24:27], v[56:59], v[128:143]
  s_waitcnt vmcnt(4)
  buffer_load_dwordx4 v[56:59], v120, s[52:55], s18 offen sc1
  buffer_load_dwordx4 v[60:63], v121, s[52:55], s18 offen sc1
  s_add_u32 s18, s18, 0x400
  s_cmp_eq_u32 s18, s58
  s_cselect_b32 s18, s56, s18
  s_waitcnt vmcnt(20) lgkmcnt(0)
  v_mfma_f32_32x32x16_bf16 v[160:175], v[16:19], v[68:71], v[160:175]
  ds_read_b64_tr_b16 v[24:25], v122 offset:10240
  ds_read_b64_tr_b16 v[26:27], v122 offset:11264
  ds_read_b64_tr_b16 v[28:29], v123 offset:10240
  ds_read_b64_tr_b16 v[30:31], v123 offset:11264
  v_mfma_f32_32x32x16_bf16 v[176:191], v[20:23], v[68:71], v[176:191]
  s_waitcnt vmcnt(4)
  s_add_u32 m0, s14, 0x2000
  s_nop 0
  buffer_load_dwordx4 v124, s[40:43], s19 offen lds
  buffer_load_dwordx4 v125, s[40:43], s19 offen offset:1024 lds
  s_add_u32 s19, s19, 0x4000
  s_cmp_eq_u32 s19, s59
  s_cselect_b32 s19, s57, s19
  v_mfma_f32_32x32x16_bf16 v[144:159], v[20:23], v[64:67], v[144:159]
  v_mfma_f32_32x32x16_bf16 v[128:143], v[16:19], v[64:67], v[128:143]
  s_waitcnt vmcnt(4)
  buffer_load_dwordx4 v[64:67], v120, s[52:55], s18 offen sc1
  buffer_load_dwordx4 v[68:71], v121, s[52:55], s18 offen sc1
  s_add_u32 s18, s18, 0x400
  s_cmp_eq_u32 s18, s58
  s_cselect_b32 s18, s56, s18
  s_waitcnt vmcnt(22) lgkmcnt(0)
  v_mfma_f32_32x32x16_bf16 v[160:175], v[24:27], v[76:79], v[160:175]
  ds_read_b64_tr_b16 v[16:17], v122 offset:12288
  ds_read_b64_tr_b16 v[18:19], v122 offset:13312
  ds_read_b64_tr_b16 v[20:21], v123 offset:12288
  ds_read_b64_tr_b16 v[22:23], v123 offset:13312
  v_mfma_f32_32x32x16_bf16 v[176:191], v[28:31], v[76:79], v[176:191]
  s_waitcnt vmcnt(4)
  s_add_u32 m0, s14, 0x2800
  s_nop 0
  buffer_load_dwordx4 v124, s[40:43], s19 offen lds
  buffer_load_dwordx4 v125, s[40:43], s19 offen offset:1024 lds
  s_add_u32 s19, s19, 0x4000
  s_cmp_eq_u32 s19, s59
  s_cselect_b32 s19, s57, s19
  v_mfma_f32_32x32x16_bf16 v[144:159], v[28:31], v[72:75], v[144:159]
  v_mfma_f32_32x32x16_bf16 v[128:143], v[24:27], v[72:75], v[128:143]
  s_waitcnt vmcnt(4)
  buffer_load_dwordx4 v[72:75], v120, s[52:55], s18 offen sc1
  buffer_load_dwordx4 v[76:79], v121, s[52:55], s18 offen sc1
  s_add_u32 s18, s18, 0x400
  s_cmp_eq_u32 s18, s58
  s_cselect_b32 s18, s56, s18
  s_waitcnt vmcnt(22) lgkmcnt(0)
  v_mfma_f32_32x32x16_bf16 v[160:175], v[16:19], v[84:87], v[160:175]
  ds_read_b64_tr_b16 v[24:25], v122 offset:0
  ds_read_b64_tr_b16 v[26:27], v122 offset:1024
  ds_read_b64_tr_b16 v[28:29], v123 offset:0
  ds_read_b64_tr_b16 v[30:31], v123 offset:1024
  v_mfma_f32_32x32x16_bf16 v[176:191], v[20:23], v[84:87], v[176:191]
  s_waitcnt vmcnt(4)
  s_add_u32 m0, s14, 0x3000
  s_nop 0
  buffer_load_dwordx4 v124, s[40:43], s19 offen lds
  buffer_load_dwordx4 v125, s[40:43], s19 offen offset:1024 lds
  s_add_u32 s19, s19, 0x4000
  s_cmp_eq_u32 s19, s59
  s_cselect_b32 s19, s57, s19
  v_mfma_f32_32x32x16_bf16 v[144:159], v[20:23], v[80:83], v[144:159]
  v_mfma_f32_32x32x16_bf16 v[128:143], v[16:19], v[80:83], v[128:143]
  s_waitcnt vmcnt(4)
  buffer_load_dwordx4 v[80:83], v120, s[52:55], s18 offen sc1
  buffer_load_dwordx4 v[84:87], v121, s[52:55], s18 offen sc1
  s_add_u32 s18, s18, 0x400
  s_cmp_eq_u32 s18, s58
  s_cselect_b32 s18, s56, s18
  s_waitcnt vmcnt(22) lgkmcnt(0)
  v_mfma_f32_32x32x16_bf16 v[160:175], v[24:27], v[36:39], v[160:175]
  ds_read_b64_tr_b16 v[16:17], v122 offset:2048
  ds_read_b64_tr_b16 v[18:19], v122 offset:3072
  ds_read_b64_tr_b16 v[20:21], v123 offset:2048
  ds_read_b64_tr_b16 v[22:23], v123 offset:3072
  v_mfma_f32_32x32x16_bf16 v[176:191], v[28:31], v[36:39], v[176:191]
  s_waitcnt vmcnt(4)
  s_add_u32 m0, s14, 0x0
  s_nop 0
  buffer_load_dwordx4 v124, s[40:43], s19 offen lds
  buffer_load_dwordx4 v125, s[40:43], s19 offen offset:1024 lds
  s_add_u32 s19, s19, 0x4000
  s_cmp_eq_u32 s19, s59
  s_cselect_b32 s19, s57, s19
  v_mfma_f32_32x32x16_bf16 v[144:159], v[28:31], v[32:35], v[144:159]
  v_mfma_f32_32x32x16_bf16 v[128:143], v[24:27], v[32:35], v[128:143]
  s_waitcnt vmcnt(4)
  buffer_load_dwordx4 v[32:35], v120, s[52:55], s18 offen sc1
  buffer_load_dwordx4 v[36:39], v121, s[52:55], s18 offen sc1
  s_add_u32 s18, s18, 0x400
  s_cmp_eq_u32 s18, s58
  s_cselect_b32 s18, s56, s18
  s_waitcnt vmcnt(22) lgkmcnt(0)
  v_mfma_f32_32x32x16_bf16 v[160:175], v[16:19], v[44:47], v[160:175]
  ds_read_b64_tr_b16 v[24:25], v122 offset:4096
  ds_read_b64_tr_b16 v[26:27], v122 offset:5120
  ds_read_b64_tr_b16 v[28:29], v123 offset:4096
  ds_read_b64_tr_b16 v[30:31], v123 offset:5120
  v_mfma_f32_32x32x16_bf16 v[176:191], v[20:23], v[44:47], v[176:191]
  s_waitcnt vmcnt(4)
  s_add_u32 m0, s14, 0x800
  s_nop 0
  buffer_load_dwordx4 v124, s[40:43], s19 offen lds
  buffer_load_dwordx4 v125, s[40:43], s19 offen offset:1024 lds
  s_add_u32 s19, s19, 0x4000
  s_cmp_eq_u32 s19, s59
  s_cselect_b32 s19, s57, s19
  v_mfma_f32_32x32x16_bf16 v[144:159], v[20:23], v[40:43], v[144:159]
  v_mfma_f32_32x32x16_bf16 v[128:143], v[16:19], v[40:43], v[128:143]
  s_waitcnt vmcnt(4)
  buffer_load_dwordx4 v[40:43], v120, s[52:55], s18 offen sc1
  buffer_load_dwordx4 v[44:47], v121, s[52:55], s18 offen sc1
  s_add_u32 s18, s18, 0x400
  s_cmp_eq_u32 s18, s58
  s_cselect_b32 s18, s56, s18
  s_waitcnt vmcnt(22) lgkmcnt(0)
  v_mfma_f32_32x32x16_bf16 v[160:175], v[24:27], v[52:55], v[160:175]
  ds_read_b64_tr_b16 v[16:17], v122 offset:6144
  ds_read_b64_tr_b16 v[18:19], v122 offset:7168
  ds_read_b64_tr_b16 v[20:21], v123 offset:6144
  ds_read_b64_tr_b16 v[22:23], v123 offset:7168
  v_mfma_f32_32x32x16_bf16 v[176:191], v[28:31], v[52:55], v[176:191]
  s_waitcnt vmcnt(4)
  s_add_u32 m0, s14, 0x1000
  s_nop 0
  buffer_load_dwordx4 v124, s[40:43], s19 offen lds
  buffer_load_dwordx4 v125, s[40:43], s19 offen offset:1024 lds
  s_add_u32 s19, s19, 0x4000
  s_cmp_eq_u32 s19, s59
  s_cselect_b32 s19, s57, s19
  v_mfma_f32_32x32x16_bf16 v[144:159], v[28:31], v[48:51], v[144:159]
  v_mfma_f32_32x32x16_bf16 v[128:143], v[24:27], v[48:51], v[128:143]
  s_waitcnt vmcnt(4)
  buffer_load_dwordx4 v[48:51], v120, s[52:55], s18 offen sc1
  buffer_load_dwordx4 v[52:55], v121, s[52:55], s18 offen sc1
  s_add_u32 s18, s18, 0x400
  s_cmp_eq_u32 s18, s58
  s_cselect_b32 s18, s56, s18
  s_waitcnt vmcnt(22) lgkmcnt(0)
  v_mfma_f32_32x32x16_bf16 v[160:175], v[16:19], v[60:63], v[160:175]
  ds_read_b64_tr_b16 v[24:25], v122 offset:8192
  ds_read_b64_tr_b16 v[26:27], v122 offset:9216
  ds_read_b64_tr_b16 v[28:29], v123 offset:8192
  ds_read_b64_tr_b16 v[30:31], v123 offset:9216
  v_mfma_f32_32x32x16_bf16 v[176:191], v[20:23], v[60:63], v[176:191]
  s_waitcnt vmcnt(4)
  s_add_u32 m0, s14, 0x1800
  s_nop 0
  buffer_load_dwordx4 v124, s[40:43], s19 offen lds
  buffer_load_dwordx4 v125, s[40:43], s19 offen offset:1024 lds
  s_add_u32 s19, s19, 0x4000
  s_cmp_eq_u32 s19, s59
  s_cselect_b32 s19, s57, s19
  v_mfma_f32_32x32x16_bf16 v[144:159], v[20:23], v[56:59], v[144:159]
  v_mfma_f32_32x32x16_bf16 v[128:143], v[16:19], v[56:59], v[128:143]
  s_waitcnt vmcnt(4)
  buffer_load_dwordx4 v[56:59], v120, s[52:55], s18 offen sc1
  buffer_load_dwordx4 v[60:63], v121, s[52:55], s18 offen sc1
  s_add_u32 s18, s18, 0x400
  s_cmp_eq_u32 s18, s58
  s_cselect_b32 s18, s56, s18
  s_waitcnt vmcnt(22) lgkmcnt(0)
  v_mfma_f32_32x32x16_bf16 v[160:175], v[24:27], v[68:71], v[160:175]
  ds_read_b64_tr_b16 v[16:17], v122 offset:10240
  ds_read_b64_tr_b16 v[18:19], v122 offset:11264
  ds_read_b64_tr_b16 v[20:21], v123 offset:10240
  ds_read_b64_tr_b16 v[22:23], v123 offset:11264
  v_mfma_f32_32x32x16_bf16 v[176:191], v[28:31], v[68:71], v[176:191]
  s_waitcnt vmcnt(4)
  s_add_u32 m0, s14, 0x2000
  s_nop 0
  buffer_load_dwordx4 v124, s[40:43], s19 offen lds
  buffer_load_dwordx4 v125, s[40:43], s19 offen offset:1024 lds
  s_add_u32 s19, s19, 0x4000
  s_cmp_eq_u32 s19, s59
  s_cselect_b32 s19, s57, s19
  v_mfma_f32_32x32x16_bf16 v[144:159], v[28:31], v[64:67], v[144:159]
  v_mfma_f32_32x32x16_bf16 v[128:143], v[24:27], v[64:67], v[128:143]
  s_waitcnt vmcnt(4)
  buffer_load_dwordx4 v[64:67], v120, s[52:55], s18 offen sc1
  buffer_load_dwordx4 v[68:71], v121, s[52:55], s18 offen sc1
  s_add_u32 s18, s18, 0x400
  s_cmp_eq_u32 s18, s58
  s_cselect_b32 s18, s56, s18
  s_waitcnt vmcnt(22) lgkmcnt(0)
  v_mfma_f32_32x32x16_bf16 v[160:175], v[16:19], v[76:79], v[160:175]
  ds_read_b64_tr_b16 v[24:25], v122 offset:12288
  ds_read_b64_tr_b16 v[26:27], v122 offset:13312
  ds_read_b64_tr_b16 v[28:29], v123 offset:12288
  ds_read_b64_tr_b16 v[30:31], v123 offset:13312
  v_mfma_f32_32x32x16_bf16 v[176:191], v[20:23], v[76:79], v[176:191]
  s_waitcnt vmcnt(4)
  s_add_u32 m0, s14, 0x2800
  s_nop 0
  buffer_load_dwordx4 v124, s[40:43], s19 offen lds
  buffer_load_dwordx4 v125, s[40:43], s19 offen offset:1024 lds
  s_add_u32 s19, s19, 0x4000
  s_cmp_eq_u32 s19, s59
  s_cselect_b32 s19, s57, s19
  v_mfma_f32_32x32x16_bf16 v[144:159], v[20:23], v[72:75], v[144:159]
  v_mfma_f32_32x32x16_bf16 v[128:143], v[16:19], v[72:75], v[128:143]
  s_waitcnt vmcnt(4)
  buffer_load_dwordx4 v[72:75], v120, s[52:55], s18 offen sc1
  buffer_load_dwordx4 v[76:79], v121, s[52:55], s18 offen sc1
  s_add_u32 s18, s18, 0x400
  s_cmp_eq_u32 s18, s58
  s_cselect_b32 s18, s56, s18
  s_waitcnt vmcnt(22) lgkmcnt(0)
  v_mfma_f32_32x32x16_bf16 v[160:175], v[24:27], v[84:87], v[160:175]
  ds_read_b64_tr_b16 v[16:17], v122 offset:0
  ds_read_b64_tr_b16 v[18:19], v122 offset:1024
  ds_read_b64_tr_b16 v[20:21], v123 offset:0
  ds_read_b64_tr_b16 v[22:23], v123 offset:1024
  v_mfma_f32_32x32x16_bf16 v[176:191], v[28:31], v[84:87], v[176:191]
  s_waitcnt vmcnt(4)
  s_add_u32 m0, s14, 0x3000
  s_nop 0
  buffer_load_dwordx4 v124, s[40:43], s19 offen lds
  buffer_load_dwordx4 v125, s[40:43], s19 offen offset:1024 lds
  s_add_u32 s19, s19, 0x4000
  s_cmp_eq_u32 s19, s59
  s_cselect_b32 s19, s57, s19
  v_mfma_f32_32x32x16_bf16 v[144:159], v[28:31], v[80:83], v[144:159]
  v_mfma_f32_32x32x16_bf16 v[128:143], v[24:27], v[80:83], v[128:143]
  s_waitcnt vmcnt(4)
  buffer_load_dwordx4 v[80:83], v120, s[52:55], s18 offen sc1
  buffer_load_dwordx4 v[84:87], v121, s[52:55], s18 offen sc1
  s_add_u32 s18, s18, 0x400
  s_cmp_eq_u32 s18, s58
  s_cselect_b32 s18, s56, s18
  s_waitcnt vmcnt(22) lgkmcnt(0)
  v_mfma_f32_32x32x16_bf16 v[160:175], v[16:19], v[36:39], v[160:175]
  ds_read_b64_tr_b16 v[24:25], v122 offset:2048
  ds_read_b64_tr_b16 v[26:27], v122 offset:3072
  ds_read_b64_tr_b16 v[28:29], v123 offset:2048
  ds_read_b64_tr_b16 v[30:31], v123 offset:3072
  v_mfma_f32_32x32x16_bf16 v[176:191], v[20:23], v[36:39], v[176:191]
  s_waitcnt vmcnt(4)
  s_add_u32 m0, s14, 0x0
  s_nop 0
  buffer_load_dwordx4 v124, s[40:43], s19 offen lds
  buffer_load_dwordx4 v125, s[40:43], s19 offen offset:1024 lds
  s_add_u32 s19, s19, 0x4000
  s_cmp_eq_u32 s19, s59
  s_cselect_b32 s19, s57, s19
  v_mfma_f32_32x32x16_bf16 v[144:159], v[20:23], v[32:35], v[144:159]
  v_mfma_f32_32x32x16_bf16 v[128:143], v[16:19], v[32:35], v[128:143]
  s_waitcnt vmcnt(4)
  buffer_load_dwordx4 v[32:35], v120, s[52:55], s18 offen sc1
  buffer_load_dwordx4 v[36:39], v121, s[52:55], s18 offen sc1
  s_add_u32 s18, s18, 0x400
  s_cmp_eq_u32 s18, s58
  s_cselect_b32 s18, s56, s18
  s_waitcnt vmcnt(22) lgkmcnt(0)
  v_mfma_f32_32x32x16_bf16 v[160:175], v[24:27], v[44:47], v[160:175]
  ds_read_b64_tr_b16 v[16:17], v122 offset:4096
  ds_read_b64_tr_b16 v[18:19], v122 offset:5120
  ds_read_b64_tr_b16 v[20:21], v123 offset:4096
  ds_read_b64_tr_b16 v[22:23], v123 offset:5120
  v_mfma_f32_32x32x16_bf16 v[176:191], v[28:31], v[44:47], v[176:191]
  s_waitcnt vmcnt(4)
  s_add_u32 m0, s14, 0x800
  s_nop 0
  buffer_load_dwordx4 v124, s[40:43], s19 offen lds
  buffer_load_dwordx4 v125, s[40:43], s19 offen offset:1024 lds
  s_add_u32 s19, s19, 0x4000
  s_cmp_eq_u32 s19, s59
  s_cselect_b32 s19, s57, s19
  v_mfma_f32_32x32x16_bf16 v[144:159], v[28:31], v[40:43], v[144:159]
  v_mfma_f32_32x32x16_bf16 v[128:143], v[24:27], v[40:43], v[128:143]
  s_waitcnt vmcnt(4)
  buffer_load_dwordx4 v[40:43], v120, s[52:55], s18 offen sc1
  buffer_load_dwordx4 v[44:47], v121, s[52:55], s18 offen sc1
  s_add_u32 s18, s18, 0x400
  s_cmp_eq_u32 s18, s58
  s_cselect_b32 s18, s56, s18
  s_waitcnt vmcnt(22) lgkmcnt(0)
  v_mfma_f32_32x32x16_bf16 v[160:175], v[16:19], v[52:55], v[160:175]
  ds_read_b64_tr_b16 v[24:25], v122 offset:6144
  ds_read_b64_tr_b16 v[26:27], v122 offset:7168
  ds_read_b64_tr_b16 v[28:29], v123 offset:6144
  ds_read_b64_tr_b16 v[30:31], v123 offset:7168
  v_mfma_f32_32x32x16_bf16 v[176:191], v[20:23], v[52:55], v[176:191]
  s_waitcnt vmcnt(4)
  s_add_u32 m0, s14, 0x1000
  s_nop 0
  buffer_load_dwordx4 v124, s[40:43], s19 offen lds
  buffer_load_dwordx4 v125, s[40:43], s19 offen offset:1024 lds
  s_add_u32 s19, s19, 0x4000
  s_cmp_eq_u32 s19, s59
  s_cselect_b32 s19, s57, s19
  v_mfma_f32_32x32x16_bf16 v[144:159], v[20:23], v[48:51], v[144:159]
  v_mfma_f32_32x32x16_bf16 v[128:143], v[16:19], v[48:51], v[128:143]
  s_waitcnt vmcnt(4)
  buffer_load_dwordx4 v[48:51], v120, s[52:55], s18 offen sc1
  buffer_load_dwordx4 v[52:55], v121, s[52:55], s18 offen sc1
  s_add_u32 s18, s18, 0x400
  s_cmp_eq_u32 s18, s58
  s_cselect_b32 s18, s56, s18
  s_waitcnt vmcnt(22) lgkmcnt(0)
  v_mfma_f32_32x32x16_bf16 v[160:175], v[24:27], v[60:63], v[160:175]
  ds_read_b64_tr_b16 v[16:17], v122 offset:8192
  ds_read_b64_tr_b16 v[18:19], v122 offset:9216
  ds_read_b64_tr_b16 v[20:21], v123 offset:8192
  ds_read_b64_tr_b16 v[22:23], v123 offset:9216
  v_mfma_f32_32x32x16_bf16 v[176:191], v[28:31], v[60:63], v[176:191]
  s_waitcnt vmcnt(4)
  s_add_u32 m0, s14, 0x1800
  s_nop 0
  buffer_load_dwordx4 v124, s[40:43], s19 offen lds
  buffer_load_dwordx4 v125, s[40:43], s19 offen offset:1024 lds
  s_add_u32 s19, s19, 0x4000
  s_cmp_eq_u32 s19, s59
  s_cselect_b32 s19, s57, s19
  v_mfma_f32_32x32x16_bf16 v[144:159], v[28:31], v[56:59], v[144:159]
  v_mfma_f32_32x32x16_bf16 v[128:143], v[24:27], v[56:59], v[128:143]
  s_waitcnt vmcnt(4)
  buffer_load_dwordx4 v[56:59], v120, s[52:55], s18 offen sc1
  buffer_load_dwordx4 v[60:63], v121, s[52:55], s18 offen sc1
  s_add_u32 s18, s18, 0x400
  s_cmp_eq_u32 s18, s58
  s_cselect_b32 s18, s56, s18
  s_waitcnt vmcnt(22) lgkmcnt(0)
  v_mfma_f32_32x32x16_bf16 v[160:175], v[16:19], v[68:71], v[160:175]
  ds_read_b64_tr_b16 v[24:25], v122 offset:10240
  ds_read_b64_tr_b16 v[26:27], v122 offset:11264
  ds_read_b64_tr_b16 v[28:29], v123 offset:10240
  ds_read_b64_tr_b16 v[30:31], v123 offset:11264
  v_mfma_f32_32x32x16_bf16 v[176:191], v[20:23], v[68:71], v[176:191]
  s_waitcnt vmcnt(4)
  s_add_u32 m0, s14, 0x2000
  s_nop 0
  buffer_load_dwordx4 v124, s[40:43], s19 offen lds
  buffer_load_dwordx4 v125, s[40:43], s19 offen offset:1024 lds
  s_add_u32 s19, s19, 0x4000
  s_cmp_eq_u32 s19, s59
  s_cselect_b32 s19, s57, s19
  v_mfma_f32_32x32x16_bf16 v[144:159], v[20:23], v[64:67], v[144:159]
  v_mfma_f32_32x32x16_bf16 v[128:143], v[16:19], v[64:67], v[128:143]
  s_waitcnt vmcnt(4)
  buffer_load_dwordx4 v[64:67], v120, s[52:55], s18 offen sc1
  buffer_load_dwordx4 v[68:71], v121, s[52:55], s18 offen sc1
  s_add_u32 s18, s18, 0x400
  s_cmp_eq_u32 s18, s58
  s_cselect_b32 s18, s56, s18
  s_waitcnt vmcnt(22) lgkmcnt(0)
  v_mfma_f32_32x32x16_bf16 v[160:175], v[24:27], v[76:79], v[160:175]
  ds_read_b64_tr_b16 v[16:17], v122 offset:12288
  ds_read_b64_tr_b16 v[18:19], v122 offset:13312
  ds_read_b64_tr_b16 v[20:21], v123 offset:12288
  ds_read_b64_tr_b16 v[22:23], v123 offset:13312
  v_mfma_f32_32x32x16_bf16 v[176:191], v[28:31], v[76:79], v[176:191]
  s_waitcnt vmcnt(4)
  s_add_u32 m0, s14, 0x2800
  s_nop 0
  buffer_load_dwordx4 v124, s[40:43], s19 offen lds
  buffer_load_dwordx4 v125, s[40:43], s19 offen offset:1024 lds
  s_add_u32 s19, s19, 0x4000
  s_cmp_eq_u32 s19, s59
  s_cselect_b32 s19, s57, s19
  v_mfma_f32_32x32x16_bf16 v[144:159], v[28:31], v[72:75], v[144:159]
  v_mfma_f32_32x32x16_bf16 v[128:143], v[24:27], v[72:75], v[128:143]
  s_waitcnt vmcnt(4)
  buffer_load_dwordx4 v[72:75], v120, s[52:55], s18 offen sc1
  buffer_load_dwordx4 v[76:79], v121, s[52:55], s18 offen sc1
  s_add_u32 s18, s18, 0x400
  s_cmp_eq_u32 s18, s58
  s_cselect_b32 s18, s56, s18
  s_waitcnt vmcnt(22) lgkmcnt(0)
  v_mfma_f32_32x32x16_bf16 v[160:175], v[16:19], v[84:87], v[160:175]
  ds_read_b64_tr_b16 v[24:25], v122 offset:0
  ds_read_b64_tr_b16 v[26:27], v122 offset:1024
  ds_read_b64_tr_b16 v[28:29], v123 offset:0
  ds_read_b64_tr_b16 v[30:31], v123 offset:1024
  v_mfma_f32_32x32x16_bf16 v[176:191], v[20:23], v[84:87], v[176:191]
  s_waitcnt vmcnt(4)
  s_add_u32 m0, s14, 0x3000
  s_nop 0
  buffer_load_dwordx4 v124, s[40:43], s19 offen lds
  buffer_load_dwordx4 v125, s[40:43], s19 offen offset:1024 lds
  s_add_u32 s19, s19, 0x4000
  s_cmp_eq_u32 s19, s59
  s_cselect_b32 s19, s57, s19
  v_mfma_f32_32x32x16_bf16 v[144:159], v[20:23], v[80:83], v[144:159]
  v_mfma_f32_32x32x16_bf16 v[128:143], v[16:19], v[80:83], v[128:143]
  s_waitcnt vmcnt(4)
  buffer_load_dwordx4 v[80:83], v120, s[52:55], s18 offen sc1
  buffer_load_dwordx4 v[84:87], v121, s[52:55], s18 offen sc1
  s_add_u32 s18, s18, 0x400
  s_cmp_eq_u32 s18, s58
  s_cselect_b32 s18, s56, s18
  s_waitcnt vmcnt(22) lgkmcnt(0)
  v_mfma_f32_32x32x16_bf16 v[160:175], v[24:27], v[36:39], v[160:175]
  ds_read_b64_tr_b16 v[16:17], v122 offset:2048
  ds_read_b64_tr_b16 v[18:19], v122 offset:3072
  ds_read_b64_tr_b16 v[20:21], v123 offset:2048
  ds_read_b64_tr_b16 v[22:23], v123 offset:3072
  v_mfma_f32_32x32x16_bf16 v[176:191], v[28:31], v[36:39], v[176:191]
  s_add_u32 m0, s14, 0x0
  s_nop 0
  buffer_load_dwordx4 v124, s[44:47], s73 offen lds
  buffer_load_dwordx4 v125, s[44:47], s73 offen offset:1024 lds
  s_add_u32 s73, s73, 0x4000
  v_mfma_f32_32x32x16_bf16 v[144:159], v[28:31], v[32:35], v[144:159]
  v_mfma_f32_32x32x16_bf16 v[128:143], v[24:27], v[32:35], v[128:143]
  s_waitcnt vmcnt(20) lgkmcnt(0)
  v_mfma_f32_32x32x16_bf16 v[160:175], v[16:19], v[44:47], v[160:175]
  ds_read_b64_tr_b16 v[24:25], v122 offset:4096
  ds_read_b64_tr_b16 v[26:27], v122 offset:5120
  ds_read_b64_tr_b16 v[28:29], v123 offset:4096
  ds_read_b64_tr_b16 v[30:31], v123 offset:5120
  v_mfma_f32_32x32x16_bf16 v[176:191], v[20:23], v[44:47], v[176:191]
  s_add_u32 m0, s14, 0x800
  s_nop 0
  buffer_load_dwordx4 v124, s[44:47], s73 offen lds
  buffer_load_dwordx4 v125, s[44:47], s73 offen offset:1024 lds
  s_add_u32 s73, s73, 0x4000
  v_mfma_f32_32x32x16_bf16 v[144:159], v[20:23], v[40:43], v[144:159]
  v_mfma_f32_32x32x16_bf16 v[128:143], v[16:19], v[40:43], v[128:143]
  s_waitcnt vmcnt(18) lgkmcnt(0)
  v_mfma_f32_32x32x16_bf16 v[160:175], v[24:27], v[52:55], v[160:175]
  ds_read_b64_tr_b16 v[16:17], v122 offset:6144
  ds_read_b64_tr_b16 v[18:19], v122 offset:7168
  ds_read_b64_tr_b16 v[20:21], v123 offset:6144
  ds_read_b64_tr_b16 v[22:23], v123 offset:7168
  v_mfma_f32_32x32x16_bf16 v[176:191], v[28:31], v[52:55], v[176:191]
  s_mov_b64 exec, 0xff
  buffer_load_dword v3, v8, s[52:55], s17 offen sc1
  s_mov_b64 exec, -1
  s_add_u32 m0, s14, 0x1000
  s_nop 0
  buffer_load_dwordx4 v124, s[44:47], s73 offen lds
  buffer_load_dwordx4 v125, s[44:47], s73 offen offset:1024 lds
  s_add_u32 s73, s73, 0x4000
  v_mfma_f32_32x32x16_bf16 v[144:159], v[28:31], v[48:51], v[144:159]
  v_mfma_f32_32x32x16_bf16 v[128:143], v[24:27], v[48:51], v[128:143]
  s_waitcnt vmcnt(17) lgkmcnt(0)
  v_mfma_f32_32x32x16_bf16 v[160:175], v[16:19], v[60:63], v[160:175]
  ds_read_b64_tr_b16 v[24:25], v122 offset:8192
  ds_read_b64_tr_b16 v[26:27], v122 offset:9216
  ds_read_b64_tr_b16 v[28:29], v123 offset:8192
  ds_read_b64_tr_b16 v[30:31], v123 offset:9216
  v_mfma_f32_32x32x16_bf16 v[176:191], v[20:23], v[60:63], v[176:191]
  s_add_u32 m0, s14, 0x1800
  s_nop 0
  buffer_load_dwordx4 v124, s[44:47], s73 offen lds
  buffer_load_dwordx4 v125, s[44:47], s73 offen offset:1024 lds
  s_add_u32 s73, s73, 0x4000
  v_mfma_f32_32x32x16_bf16 v[144:159], v[20:23], v[56:59], v[144:159]
  v_mfma_f32_32x32x16_bf16 v[128:143], v[16:19], v[56:59], v[128:143]
  s_waitcnt vmcnt(4)
  s_setprio 3
  s_mov_b64 exec, 0xff
  v_cmp_ne_u32 vcc, s75, v3
  s_mov_b64 exec, -1
  s_setprio 0
  s_cbranch_vccnz L_o_late
  buffer_load_dwordx4 v[192:195], v12, s[52:55], s70 offen offset:0 sc1
  buffer_load_dwordx4 v[196:199], v13, s[52:55], s70 offen offset:0 sc1
  buffer_load_dwordx4 v[200:203], v12, s[52:55], s70 offen offset:1024 sc1
  buffer_load_dwordx4 v[204:207], v13, s[52:55], s70 offen offset:1024 sc1
  buffer_load_dwordx4 v[208:211], v12, s[52:55], s70 offen offset:2048 sc1
  buffer_load_dwordx4 v[212:215], v13, s[52:55], s70 offen offset:2048 sc1
  buffer_load_dwordx4 v[216:219], v12, s[52:55], s70 offen offset:3072 sc1
  buffer_load_dwordx4 v[220:223], v13, s[52:55], s70 offen offset:3072 sc1
  buffer_load_dwordx4 v[224:227], v12, s[52:55], s69 offen offset:0 sc1
  buffer_load_dwordx4 v[228:231], v13, s[52:55], s69 offen offset:0 sc1
  buffer_load_dwordx4 v[232:235], v12, s[52:55], s69 offen offset:1024 sc1
  buffer_load_dwordx4 v[236:239], v13, s[52:55], s69 offen offset:1024 sc1
  buffer_load_dwordx4 v[240:243], v12, s[52:55], s69 offen offset:2048 sc1
  buffer_load_dwordx4 v[244:247], v13, s[52:55], s69 offen offset:2048 sc1
  buffer_load_dwordx4 v[248:251], v12, s[52:55], s69 offen offset:3072 sc1
  buffer_load_dwordx4 v[252:255], v13, s[52:55], s69 offen offset:3072 sc1
L_o_late:
  s_waitcnt lgkmcnt(0)
  v_mfma_f32_32x32x16_bf16 v[160:175], v[24:27], v[68:71], v[160:175]
  ds_read_b64_tr_b16 v[16:17], v122 offset:10240
  ds_read_b64_tr_b16 v[18:19], v122 offset:11264
  ds_read_b64_tr_b16 v[20:21], v123 offset:10240
  ds_read_b64_tr_b16 v[22:23], v123 offset:11264
  v_mfma_f32_32x32x16_bf16 v[176:191], v[28:31], v[68:71], v[176:191]
  v_mfma_f32_32x32x16_bf16 v[144:159], v[28:31], v[64:67], v[144:159]
  v_mfma_f32_32x32x16_bf16 v[128:143], v[24:27], v[64:67], v[128:143]
  s_waitcnt lgkmcnt(0)
  v_mfma_f32_32x32x16_bf16 v[160:175], v[16:19], v[76:79], v[160:175]
  ds_read_b64_tr_b16 v[24:25], v122 offset:12288
  ds_read_b64_tr_b16 v[26:27], v122 offset:13312
  ds_read_b64_tr_b16 v[28:29], v123 offset:12288
  ds_read_b64_tr_b16 v[30:31], v123 offset:13312
  v_mfma_f32_32x32x16_bf16 v[176:191], v[20:23], v[76:79], v[176:191]
  v_mfma_f32_32x32x16_bf16 v[144:159], v[20:23], v[72:75], v[144:159]
  v_mfma_f32_32x32x16_bf16 v[128:143], v[16:19], v[72:75], v[128:143]
  s_waitcnt lgkmcnt(0)
  v_mfma_f32_32x32x16_bf16 v[160:175], v[24:27], v[84:87], v[160:175]
  ds_read_b64_tr_b16 v[16:17], v122 offset:14336
  ds_read_b64_tr_b16 v[18:19], v122 offset:15360
  ds_read_b64_tr_b16 v[20:21], v123 offset:14336
  ds_read_b64_tr_b16 v[22:23], v123 offset:15360
  v_mfma_f32_32x32x16_bf16 v[176:191], v[28:31], v[84:87], v[176:191]
  v_mfma_f32_32x32x16_bf16 v[144:159], v[28:31], v[80:83], v[144:159]
  v_mfma_f32_32x32x16_bf16 v[128:143], v[24:27], v[80:83], v[128:143]
  s_setprio 3
  s_cbranch_vccz L_o_have
  s_mov_b32 s3, 0
  s_mov_b32 exec_lo, 0xff
  s_mov_b32 exec_hi, 0
L_poll_o:
  buffer_load_dword v3, v8, s[52:55], s17 offen sc1
  s_add_u32 s3, s3, 1
  s_waitcnt vmcnt(0)
  v_cmp_ne_u32 vcc, s75, v3
  s_cmp_gt_u32 s3, 0x40000
  s_cbranch_vccz L_polld_o
  s_cbranch_scc1 L_polld_o
  s_sleep 2
  s_branch L_poll_o
L_polld_o:
  s_mov_b64 exec, -1
  buffer_load_dwordx4 v[192:195], v12, s[52:55], s70 offen offset:0 sc1
  buffer_load_dwordx4 v[196:199], v13, s[52:55], s70 offen offset:0 sc1
  buffer_load_dwordx4 v[200:203], v12, s[52:55], s70 offen offset:1024 sc1
  buffer_load_dwordx4 v[204:207], v13, s[52:55], s70 offen offset:1024 sc1
  buffer_load_dwordx4 v[208:211], v12, s[52:55], s70 offen offset:2048 sc1
  buffer_load_dwordx4 v[212:215], v13, s[52:55], s70 offen offset:2048 sc1
  buffer_load_dwordx4 v[216:219], v12, s[52:55], s70 offen offset:3072 sc1
  buffer_load_dwordx4 v[220:223], v13, s[52:55], s70 offen offset:3072 sc1
  buffer_load_dwordx4 v[224:227], v12, s[52:55], s69 offen offset:0 sc1
  buffer_load_dwordx4 v[228:231], v13, s[52:55], s69 offen offset:0 sc1
  buffer_load_dwordx4 v[232:235], v12, s[52:55], s69 offen offset:1024 sc1
  buffer_load_dwordx4 v[236:239], v13, s[52:55], s69 offen offset:1024 sc1
  buffer_load_dwordx4 v[240:243], v12, s[52:55], s69 offen offset:2048 sc1
  buffer_load_dwordx4 v[244:247], v13, s[52:55], s69 offen offset:2048 sc1
  buffer_load_dwordx4 v[248:251], v12, s[52:55], s69 offen offset:3072 sc1
  buffer_load_dwordx4 v[252:255], v13, s[52:55], s69 offen offset:3072 sc1
L_o_have:
  s_waitcnt vmcnt(14) lgkmcnt(0)
  v_mfma_f32_32x32x16_bf16 v[160:175], v[16:19], v[196:199], v[160:175]
  ds_read_b64_tr_b16 v[24:25], v14 offset:0
  ds_read_b64_tr_b16 v[26:27], v14 offset:1024
  ds_read_b64_tr_b16 v[28:29], v15 offset:0
  ds_read_b64_tr_b16 v[30:31], v15 offset:1024
  v_mfma_f32_32x32x16_bf16 v[176:191], v[20:23], v[196:199], v[176:191]
  v_mfma_f32_32x32x16_bf16 v[144:159], v[20:23], v[192:195], v[144:159]
  v_mfma_f32_32x32x16_bf16 v[128:143], v[16:19], v[192:195], v[128:143]
  s_waitcnt vmcnt(12) lgkmcnt(0)
  v_mfma_f32_32x32x16_bf16 v[160:175], v[24:27], v[204:207], v[160:175]
  ds_read_b64_tr_b16 v[16:17], v14 offset:2048
  ds_read_b64_tr_b16 v[18:19], v14 offset:3072
  ds_read_b64_tr_b16 v[20:21], v15 offset:2048
  ds_read_b64_tr_b16 v[22:23], v15 offset:3072
  v_mfma_f32_32x32x16_bf16 v[176:191], v[28:31], v[204:207], v[176:191]
  v_mfma_f32_32x32x16_bf16 v[144:159], v[28:31], v[200:203], v[144:159]
  v_mfma_f32_32x32x16_bf16 v[128:143], v[24:27], v[200:203], v[128:143]
  s_waitcnt vmcnt(10) lgkmcnt(0)
  v_mfma_f32_32x32x16_bf16 v[160:175], v[16:19], v[212:215], v[160:175]
  ds_read_b64_tr_b16 v[24:25], v14 offset:4096
  ds_read_b64_tr_b16 v[26:27], v14 offset:5120
  ds_read_b64_tr_b16 v[28:29], v15 offset:4096
  ds_read_b64_tr_b16 v[30:31], v15 offset:5120
  v_mfma_f32_32x32x16_bf16 v[176:191], v[20:23], v[212:215], v[176:191]
  v_mfma_f32_32x32x16_bf16 v[144:159], v[20:23], v[208:211], v[144:159]
  v_mfma_f32_32x32x16_bf16 v[128:143], v[16:19], v[208:211], v[128:143]
  s_waitcnt vmcnt(8) lgkmcnt(0)
  v_mfma_f32_32x32x16_bf16 v[160:175], v[24:27], v[220:223], v[160:175]
  ds_read_b64_tr_b16 v[16:17], v122 offset:0
  ds_read_b64_tr_b16 v[18:19], v122 offset:1024
  ds_read_b64_tr_b16 v[20:21], v123 offset:0
  ds_read_b64_tr_b16 v[22:23], v123 offset:1024
  v_mfma_f32_32x32x16_bf16 v[176:191], v[28:31], v[220:223], v[176:191]
  v_mfma_f32_32x32x16_bf16 v[144:159], v[28:31], v[216:219], v[144:159]
  v_mfma_f32_32x32x16_bf16 v[128:143], v[24:27], v[216:219], v[128:143]
  s_waitcnt vmcnt(6) lgkmcnt(0)
  v_mfma_f32_32x32x16_bf16 v[160:175], v[16:19], v[228:231], v[160:175]
  ds_read_b64_tr_b16 v[24:25], v122 offset:2048
  ds_read_b64_tr_b16 v[26:27], v122 offset:3072
  ds_read_b64_tr_b16 v[28:29], v123 offset:2048
  ds_read_b64_tr_b16 v[30:31], v123 offset:3072
  v_mfma_f32_32x32x16_bf16 v[176:191], v[20:23], v[228:231], v[176:191]
  v_mfma_f32_32x32x16_bf16 v[144:159], v[20:23], v[224:227], v[144:159]
  v_mfma_f32_32x32x16_bf16 v[128:143], v[16:19], v[224:227], v[128:143]
  s_waitcnt vmcnt(4) lgkmcnt(0)
  v_mfma_f32_32x32x16_bf16 v[160:175], v[24:27], v[236:239], v[160:175]
  ds_read_b64_tr_b16 v[16:17], v122 offset:4096
  ds_read_b64_tr_b16 v[18:19], v122 offset:5120
  ds_read_b64_tr_b16 v[20:21], v123 offset:4096
  ds_read_b64_tr_b16 v[22:23], v123 offset:5120
  v_mfma_f32_32x32x16_bf16 v[176:191], v[28:31], v[236:239], v[176:191]
  v_mfma_f32_32x32x16_bf16 v[144:159], v[28:31], v[232:235], v[144:159]
  v_mfma_f32_32x32x16_bf16 v[128:143], v[24:27], v[232:235], v[128:143]
  s_waitcnt vmcnt(2) lgkmcnt(0)
  v_mfma_f32_32x32x16_bf16 v[160:175], v[16:19], v[244:247], v[160:175]
  ds_read_b64_tr_b16 v[24:25], v122 offset:6144
  ds_read_b64_tr_b16 v[26:27], v122 offset:7168
  ds_read_b64_tr_b16 v[28:29], v123 offset:6144
  ds_read_b64_tr_b16 v[30:31], v123 offset:7168
  v_mfma_f32_32x32x16_bf16 v[176:191], v[20:23], v[244:247], v[176:191]
  v_mfma_f32_32x32x16_bf16 v[144:159], v[20:23], v[240:243], v[144:159]
  v_mfma_f32_32x32x16_bf16 v[128:143], v[16:19], v[240:243], v[128:143]
  s_waitcnt vmcnt(0) lgkmcnt(0)
  v_mfma_f32_32x32x16_bf16 v[160:175], v[24:27], v[252:255], v[160:175]
  v_mfma_f32_32x32x16_bf16 v[176:191], v[28:31], v[252:255], v[176:191]
  v_mfma_f32_32x32x16_bf16 v[144:159], v[28:31], v[248:251], v[144:159]
  v_mfma_f32_32x32x16_bf16 v[128:143], v[24:27], v[248:251], v[128:143]
  s_nop 8
  ds_write_b128 v4, v[160:163] offset:4096
  ds_write_b128 v4, v[164:167] offset:5120
  ds_write_b128 v4, v[168:171] offset:6144
  ds_write_b128 v4, v[172:175] offset:7168
  ds_write_b128 v4, v[176:179] offset:8192
  ds_write_b128 v4, v[180:183] offset:9216
  ds_write_b128 v4, v[184:187] offset:10240
  ds_write_b128 v4, v[188:191] offset:11264
  ds_write_b128 v4, v[144:147] offset:0
  ds_write_b128 v4, v[148:151] offset:1024
  ds_write_b128 v4, v[152:155] offset:2048
  ds_write_b128 v4, v[156:159] offset:3072
  s_waitcnt lgkmcnt(0)
  s_barrier
  ds_read_b128 v[32:35], v5 offset:0
  ds_read_b128 v[36:39], v5 offset:1024
  ds_read_b128 v[40:43], v5 offset:2048
  ds_read_b128 v[44:47], v5 offset:3072
  ds_read_b128 v[48:51], v6 offset:4096
  ds_read_b128 v[52:55], v6 offset:5120
  ds_read_b128 v[56:59], v6 offset:6144
  ds_read_b128 v[60:63], v6 offset:7168
  ds_read_b128 v[64:67], v7 offset:8192
  ds_read_b128 v[68:71], v7 offset:9216
  ds_read_b128 v[72:75], v7 offset:10240
  ds_read_b128 v[76:79], v7 offset:11264
  s_waitcnt lgkmcnt(8)
  v_pk_add_f32 v[128:129], v[128:129], v[32:33]
  v_pk_add_f32 v[130:131], v[130:131], v[34:35]
  v_pk_add_f32 v[132:133], v[132:133], v[36:37]
  v_pk_add_f32 v[134:135], v[134:135], v[38:39]
  v_pk_add_f32 v[136:137], v[136:137], v[40:41]
  v_pk_add_f32 v[138:139], v[138:139], v[42:43]
  v_pk_add_f32 v[140:141], v[140:141], v[44:45]
  v_pk_add_f32 v[142:143], v[142:143], v[46:47]
  s_waitcnt lgkmcnt(4)
  v_pk_add_f32 v[128:129], v[128:129], v[48:49]
  v_pk_add_f32 v[130:131], v[130:131], v[50:51]
  v_pk_add_f32 v[132:133], v[132:133], v[52:53]
  v_pk_add_f32 v[134:135], v[134:135], v[54:55]
  v_pk_add_f32 v[136:137], v[136:137], v[56:57]
  v_pk_add_f32 v[138:139], v[138:139], v[58:59]
  v_pk_add_f32 v[140:141], v[140:141], v[60:61]
  v_pk_add_f32 v[142:143], v[142:143], v[62:63]
  s_waitcnt lgkmcnt(0)
  v_pk_add_f32 v[128:129], v[128:129], v[64:65]
  v_pk_add_f32 v[130:131], v[130:131], v[66:67]
  v_pk_add_f32 v[132:133], v[132:133], v[68:69]
  v_pk_add_f32 v[134:135], v[134:135], v[70:71]
  v_pk_add_f32 v[136:137], v[136:137], v[72:73]
  v_pk_add_f32 v[138:139], v[138:139], v[74:75]
  v_pk_add_f32 v[140:141], v[140:141], v[76:77]
  v_pk_add_f32 v[142:143], v[142:143], v[78:79]
  v_cvt_pk_bf16_f32 v16, v128, v129
  v_cvt_pk_bf16_f32 v17, v130, v131
  v_cvt_pk_bf16_f32 v18, v132, v133
  v_cvt_pk_bf16_f32 v19, v134, v135
  v_cvt_pk_bf16_f32 v20, v136, v137
  v_cvt_pk_bf16_f32 v21, v138, v139
  v_cvt_pk_bf16_f32 v22, v140, v141
  v_cvt_pk_bf16_f32 v23, v142, v143
  s_lshl2_add_u32 s3, s2, s60
  v_permlane32_swap_b32 v16, v18
  v_permlane32_swap_b32 v17, v19
  v_permlane32_swap_b32 v20, v22
  v_permlane32_swap_b32 v21, v23
  buffer_store_dwordx4 v[16:19], v127, s[48:51], s74 offen
  buffer_store_dwordx4 v[20:23], v127, s[48:51], s74 offen offset:32
  s_cmp_lg_u32 s3, 0
  s_cbranch_scc1 L_dn_end
  s_mov_b32 s68, 0x0
  s_mov_b64 exec, 1
  buffer_store_dword v110, v111, s[52:55], s68 offen sc1
  s_mov_b64 exec, -1
L_dn_end:
  s_endpgm
L_code_end:
L_at_slow:
  s_lshl_b32 s70, s63, 17
  s_add_u32 s70, s70, 0x300000
  s_add_u32 s56, s22, s70
  s_addc_u32 s57, s23, 0
  s_mov_b32 s58, 0x20000
  s_mov_b32 s59, 0x20000
  s_mov_b32 s67, 0
L_sl_tile:
  v_mov_b32 v124, 0xff800000
  s_mov_b32 s71, 0
L_sl_max:
  buffer_load_dwordx4 v[76:79], v2, s[56:59], s71 offen sc1
  s_waitcnt vmcnt(0)
  v_mfma_f32_32x32x16_bf16 v[36:51], v[76:79], v[28:31], 0
  s_nop 11
  v_max3_f32 v124, v124, v36, v37
  v_max3_f32 v124, v124, v38, v39
  v_max3_f32 v124, v124, v40, v41
  v_max3_f32 v124, v124, v42, v43
  v_max3_f32 v124, v124, v44, v45
  v_max3_f32 v124, v124, v46, v47
  v_max3_f32 v124, v124, v48, v49
  v_max3_f32 v124, v124, v50, v51
  s_add_u32 s71, s71, 0x800
  s_cmp_lt_u32 s71, 0x20000
  s_cbranch_scc1 L_sl_max
  v_mov_b32 v125, v124
  s_nop 1
  v_permlane32_swap_b32 v124, v125
  s_nop 1
  v_max_f32 v124, v124, v125
  v_mov_b32 v224, 0
  v_mov_b32 v225, 0
  v_mov_b32 v226, 0
  v_mov_b32 v227, 0
  v_mov_b32 v228, 0
  v_mov_b32 v229, 0
  v_mov_b32 v230, 0
  v_mov_b32 v231, 0
  v_mov_b32 v232, 0
  v_mov_b32 v233, 0
  v_mov_b32 v234, 0
  v_mov_b32 v235, 0
  v_mov_b32 v236, 0
  v_mov_b32 v237, 0
  v_mov_b32 v238, 0
  v_mov_b32 v239, 0
  s_mov_b32 s71, 0
L_sl_acc:
  buffer_load_dwordx4 v[76:79], v2, s[56:59], s71 offen sc1
  s_mov_b64 exec, s[76:77]
  buffer_load_dwordx4 v[80:83], v3, s[56:59], s71 offen offset:1024 sc1
  buffer_load_dwordx4 v[84:87], v3, s[56:59], s71 offen offset:1536 sc1
  s_mov_b64 exec, -1
  s_waitcnt vmcnt(0)
  v_mfma_f32_32x32x16_bf16 v[36:51], v[76:79], v[28:31], 0
  s_nop 11
  v_sub_f32 v36, v36, v124
  v_sub_f32 v37, v37, v124
  v_sub_f32 v38, v38, v124
  v_sub_f32 v39, v39, v124
  v_sub_f32 v40, v40, v124
  v_sub_f32 v41, v41, v124
  v_sub_f32 v42, v42, v124
  v_sub_f32 v43, v43, v124
  v_sub_f32 v44, v44, v124
  v_sub_f32 v45, v45, v124
  v_sub_f32 v46, v46, v124
  v_sub_f32 v47, v47, v124
  v_sub_f32 v48, v48, v124
  v_sub_f32 v49, v49, v124
  v_sub_f32 v50, v50, v124
  v_sub_f32 v51, v51, v124
  v_exp_f32 v36, v36
  v_exp_f32 v37, v37
  v_exp_f32 v38, v38
  v_exp_f32 v39, v39
  v_exp_f32 v40, v40
  v_exp_f32 v41, v41
  v_exp_f32 v42, v42
  v_exp_f32 v43, v43
  v_exp_f32 v44, v44
  v_exp_f32 v45, v45
  v_exp_f32 v46, v46
  v_exp_f32 v47, v47
  v_exp_f32 v48, v48
  v_exp_f32 v49, v49
  v_exp_f32 v50, v50
  v_exp_f32 v51, v51
  s_nop 0
  v_cvt_pk_bf16_f32 v68, v36, v37
  v_cvt_pk_bf16_f32 v69, v38, v39
  v_cvt_pk_bf16_f32 v70, v40, v41
  v_cvt_pk_bf16_f32 v71, v42, v43
  v_cvt_pk_bf16_f32 v72, v44, v45
  v_cvt_pk_bf16_f32 v73, v46, v47
  v_cvt_pk_bf16_f32 v74, v48, v49
  v_cvt_pk_bf16_f32 v75, v50, v51
  s_nop 1
  v_mfma_f32_32x32x16_bf16 v[224:239], v[80:83], v[68:71], v[224:239]
  v_mfma_f32_32x32x16_bf16 v[224:239], v[84:87], v[72:75], v[224:239]
  s_add_u32 s71, s71, 0x800
  s_cmp_lt_u32 s71, 0x20000
  s_cbranch_scc1 L_sl_acc
  s_nop 11
  s_cmp_eq_u32 s67, 1
  s_cbranch_scc1 L_sl_done
  v_mov_b32 v128, v224
  v_mov_b32 v129, v225
  v_mov_b32 v130, v226
  v_mov_b32 v131, v227
  v_mov_b32 v132, v228
  v_mov_b32 v133, v229
  v_mov_b32 v134, v230
  v_mov_b32 v135, v231
  v_mov_b32 v136, v232
  v_mov_b32 v28, v32
  v_mov_b32 v29, v33
  v_mov_b32 v30, v34
  v_mov_b32 v31, v35
  s_mov_b32 s67, 1
  s_branch L_sl_tile
L_sl_done:
  v_mov_b32 v240, v224
  v_mov_b32 v224, v128
  v_mov_b32 v241, v225
  v_mov_b32 v225, v129
  v_mov_b32 v242, v226
  v_mov_b32 v226, v130
  v_mov_b32 v243, v227
  v_mov_b32 v227, v131
  v_mov_b32 v244, v228
  v_mov_b32 v228, v132
  v_mov_b32 v245, v229
  v_mov_b32 v229, v133
  v_mov_b32 v246, v230
  v_mov_b32 v230, v134
  v_mov_b32 v247, v231
  v_mov_b32 v231, v135
  v_mov_b32 v248, v232
  v_mov_b32 v232, v136
  s_branch L_at_norm
.section .rodata,"a"
.p2align 6
.amdhsa_kernel parallel_sum__softmax_full_mha__glu_gated_reglu__prompt_kernel
  .amdhsa_next_free_vgpr 256
  .amdhsa_next_free_sgpr 102
  .amdhsa_accum_offset 256
  .amdhsa_group_segment_fixed_size 0
  .amdhsa_kernarg_size 80
  .amdhsa_user_sgpr_count 2
  .amdhsa_user_sgpr_kernarg_segment_ptr 1
  .amdhsa_system_sgpr_workgroup_id_x 1
.end_amdhsa_kernel
```
